```python
import torch

def _softmax(x, axis=-1):
    return torch.softmax(x, dim=axis)
def _gelu(x):
    return torch.nn.functional.gelu(x, approximate="tanh")
def _silu(x):
    return torch.nn.functional.silu(x)
def _sigmoid(x):
    return torch.sigmoid(x)
def _layernorm(x, axis=-1, eps=1e-5):
    m = x.mean(dim=axis, keepdim=True)
    v = x.var(dim=axis, keepdim=True, unbiased=False)
    return (x - m) / torch.sqrt(v + eps)
def _scatter_add(tgt, idx, src, axis=0):
    return tgt.clone().index_add_(axis, idx, src)
def _segment_sum(src, seg, n):
    out = torch.zeros((n,) + src.shape[1:], dtype=src.dtype)
    return out.index_add_(0, seg, src)
def _pad(x, pw):
    flat = tuple(v for pair in reversed(pw) for v in pair)
    return torch.nn.functional.pad(x, flat)

kernel_name = 'sequential_preLN__sliding_block__dense_activation_relu__prompt'

def setup_inputs():

    _w = (lambda a: (lambda t: t.to(torch.bfloat16) if t.is_floating_point() else t)(torch.as_tensor(a)))
    def _A_setup():
        B, S, D = 1, 2048, 640
        return {
            "x": _w((lambda *s: torch.randn(*s, dtype=torch.bfloat16) * 0.05)(B, S, D)),
            "wqkv": _w((lambda *s: torch.randn(*s, dtype=torch.bfloat16) * 0.05)(D, 3 * D)),
            "wo": _w((lambda *s: torch.randn(*s, dtype=torch.bfloat16) * 0.05)(D, D)),
        }
    _A_in = _A_setup()

    def _B_setup():
        B, S, D, Dff = 1, 2048, 640, 1728
        return {
            "x": _w((lambda *s: torch.randn(*s, dtype=torch.bfloat16) * 0.05)(B, S, D)),
            "w1": _w((lambda *s: torch.randn(*s, dtype=torch.bfloat16) * 0.05)(D, Dff)),
            "w2": _w((lambda *s: torch.randn(*s, dtype=torch.bfloat16) * 0.05)(Dff, D)),
        }
    _B_in = _B_setup()

    return {
        "A_x": _A_in["x"],
        "A_wqkv": _A_in["wqkv"],
        "A_wo": _A_in["wo"],
        "B_x": _B_in["x"],
        "B_w1": _B_in["w1"],
        "B_w2": _B_in["w2"],
    }

def reference(A_x, A_wqkv, A_wo, B_x, B_w1, B_w2):
    def _A_ref(x, wqkv, wo):
        B, S, D = x.shape
        H = 32; Dh = D // H; W = 256
        qkv = (lambda x, *d: x.permute(*d))((x @ wqkv).reshape(B, S, 3, H, Dh), 2, 0, 3, 1, 4)
        q, k, v = qkv[0], qkv[1], qkv[2]
        scores = torch.einsum("bhqd,bhkd->bhqk", q, k) * (Dh ** -0.5)
        idx = torch.arange(S)
        mask = (idx[:, None] - idx[None, :] >= 0) & (idx[:, None] - idx[None, :] < W)
        scores = torch.where(mask[None, None], scores, -1e9)
        p = _softmax(scores, axis=-1)
        o = torch.einsum("bhqk,bhkd->bhqd", p, v)
        return (lambda x, *d: x.permute(*d))(o, 0, 2, 1, 3).reshape(B, S, D) @ wo

    def _B_ref(x, w1, w2):
        h = torch.einsum("bsd,df->bsf", x, w1)
        zero = torch.zeros_like(h)
        h = torch.maximum(h, zero)
        return torch.einsum("bsf,fd->bsd", h, w2)

    x = A_x
    h = x + _A_ref(_layernorm(x, axis=-1), A_wqkv, A_wo)
    h2 = h + _B_ref(_layernorm(h, axis=-1), B_w1, B_w2)
    return h2
```

```asm
; @launch grid=(256,1,1) block=(512,1,1) lds=163840
.amdgcn_target "amdgcn-amd-amdhsa--gfx950"
.text
.globl sequential_preLN__sliding_block__dense_activation_relu__prompt_kernel
.p2align 8
.type sequential_preLN__sliding_block__dense_activation_relu__prompt_kernel,@function
sequential_preLN__sliding_block__dense_activation_relu__prompt_kernel:
  s_cmp_ge_u32 s2, 256
  s_cbranch_scc1 L_end_1
  s_load_dwordx16 s[44:59], s[0:1], 0
  s_load_dwordx2 s[60:61], s[0:1], 64
  v_and_b32 v1, 63, v0
  v_lshrrev_b32 v4, 6, v0
  v_lshrrev_b32 v2, 4, v1
  v_and_b32 v3, 15, v1
  v_readfirstlane_b32 s20, v4
  s_and_b32 s39, s2, 7
  s_lshl_b32 s21, s39, 1
  s_bfe_u32 s39, s2, 0x10003
  s_add_u32 s21, s21, s39
  s_lshr_b32 s22, s2, 4
  s_and_b32 s23, s20, 3
  s_waitcnt lgkmcnt(0)
  s_mov_b32 s24, s58
  s_and_b32 s25, s59, 0xffff
  s_mov_b32 s26, 0x100
  s_mov_b32 s27, 0x20000
  s_lshl_b32 s39, s2, 3
  s_or_b32 s39, s39, s20
  s_cmp_lg_u32 s39, 0
  s_cbranch_scc1 L_notag_2
  s_memrealtime s[90:91]
  s_memtime s[86:87]
  s_waitcnt lgkmcnt(0)
  s_or_b32 s90, s90, 1
  s_xor_b32 s91, s91, s86
  v_mov_b32 v12, s90
  v_mov_b32 v13, s91
  v_mov_b32 v4, 0
  s_mov_b64 exec, 1
  buffer_store_dwordx2 v[12:13], v4, s[24:27], 0 offen sc1
  s_mov_b64 exec, -1
L_notag_2:
  s_and_b32 s39, s2, 3
  s_lshl_b32 s21, s39, 2
  s_bfe_u32 s39, s2, 0x20003
  s_add_u32 s21, s21, s39
  s_bfe_u32 s39, s2, 0x10002
  s_lshl_b32 s22, s39, 3
  s_lshr_b32 s39, s2, 5
  s_add_u32 s22, s22, s39
  s_cmp_ge_u32 s20, 4
  s_cbranch_scc1 L_nopf_3
  s_lshl_b32 s39, s2, 2
  s_add_u32 s39, s39, s20
  s_mul_i32 s40, s39, 2560
  s_mul_i32 s41, s39, 2432
  s_lshl_b32 s42, s39, 5
  s_mov_b32 s4, s44
  s_and_b32 s5, s45, 0xffff
  s_mov_b32 s6, 0x280000
  s_mov_b32 s7, 0x20000
  s_mov_b32 s8, s46
  s_and_b32 s9, s47, 0xffff
  s_mov_b32 s10, 0x258000
  s_mov_b32 s11, 0x20000
  s_add_u32 s12, s60, 0x1a40000
  s_addc_u32 s13, s61, 0
  s_and_b32 s13, s13, 0xffff
  s_mov_b32 s14, 0x8000
  s_mov_b32 s15, 0x20000
  v_lshrrev_b32 v5, 5, v1
  v_and_b32 v6, 31, v1
  v_mul_u32_u24 v4, 1280, v5
  v_lshl_add_u32 v4, v6, 4, v4
  v_cmp_gt_u32 vcc, 16, v6
  v_add_u32 v7, 1024, v4
  v_mov_b32 v230, 0x4000000
  v_lshlrev_b32 v231, 4, v5
  v_cndmask_b32 v7, v230, v7, vcc
  buffer_load_dwordx4 v[200:203], v4, s[4:7], s40 offen
  buffer_load_dwordx4 v[204:207], v4, s[4:7], s40 offen offset:512
  buffer_load_dwordx4 v[208:211], v7, s[4:7], s40 offen
  v_mov_b32 v4, 0
  buffer_load_dwordx2 v[8:9], v4, s[24:27], 0 offen sc1
  v_lshlrev_b32 v4, 4, v1
  buffer_load_dwordx4 v[248:251], v4, s[8:11], s41 offen offset:0
  buffer_load_dwordx4 v[252:255], v4, s[8:11], s41 offen offset:1024
  buffer_load_dwordx4 v[248:251], v4, s[8:11], s41 offen offset:2048
  s_waitcnt vmcnt(4)
  v_lshlrev_b32 v5, 16, v200
  v_and_b32 v6, 0xffff0000, v200
  v_add_f32 v212, v5, v6
  v_mul_f32 v213, v5, v5
  v_fmac_f32 v213, v6, v6
  v_lshlrev_b32 v5, 16, v201
  v_and_b32 v6, 0xffff0000, v201
  v_add_f32 v212, v212, v5
  v_fmac_f32 v213, v5, v5
  v_add_f32 v212, v212, v6
  v_fmac_f32 v213, v6, v6
  v_lshlrev_b32 v5, 16, v202
  v_and_b32 v6, 0xffff0000, v202
  v_add_f32 v212, v212, v5
  v_fmac_f32 v213, v5, v5
  v_add_f32 v212, v212, v6
  v_fmac_f32 v213, v6, v6
  v_lshlrev_b32 v5, 16, v203
  v_and_b32 v6, 0xffff0000, v203
  v_add_f32 v212, v212, v5
  v_fmac_f32 v213, v5, v5
  v_add_f32 v212, v212, v6
  v_fmac_f32 v213, v6, v6
  v_lshlrev_b32 v5, 16, v204
  v_and_b32 v6, 0xffff0000, v204
  v_add_f32 v212, v212, v5
  v_fmac_f32 v213, v5, v5
  v_add_f32 v212, v212, v6
  v_fmac_f32 v213, v6, v6
  v_lshlrev_b32 v5, 16, v205
  v_and_b32 v6, 0xffff0000, v205
  v_add_f32 v212, v212, v5
  v_fmac_f32 v213, v5, v5
  v_add_f32 v212, v212, v6
  v_fmac_f32 v213, v6, v6
  v_lshlrev_b32 v5, 16, v206
  v_and_b32 v6, 0xffff0000, v206
  v_add_f32 v212, v212, v5
  v_fmac_f32 v213, v5, v5
  v_add_f32 v212, v212, v6
  v_fmac_f32 v213, v6, v6
  v_lshlrev_b32 v5, 16, v207
  v_and_b32 v6, 0xffff0000, v207
  v_add_f32 v212, v212, v5
  v_fmac_f32 v213, v5, v5
  v_add_f32 v212, v212, v6
  v_fmac_f32 v213, v6, v6
  v_lshlrev_b32 v5, 16, v208
  v_and_b32 v6, 0xffff0000, v208
  v_add_f32 v212, v212, v5
  v_fmac_f32 v213, v5, v5
  v_add_f32 v212, v212, v6
  v_fmac_f32 v213, v6, v6
  v_lshlrev_b32 v5, 16, v209
  v_and_b32 v6, 0xffff0000, v209
  v_add_f32 v212, v212, v5
  v_fmac_f32 v213, v5, v5
  v_add_f32 v212, v212, v6
  v_fmac_f32 v213, v6, v6
  v_lshlrev_b32 v5, 16, v210
  v_and_b32 v6, 0xffff0000, v210
  v_add_f32 v212, v212, v5
  v_fmac_f32 v213, v5, v5
  v_add_f32 v212, v212, v6
  v_fmac_f32 v213, v6, v6
  v_lshlrev_b32 v5, 16, v211
  v_and_b32 v6, 0xffff0000, v211
  v_add_f32 v212, v212, v5
  v_fmac_f32 v213, v5, v5
  v_add_f32 v212, v212, v6
  v_fmac_f32 v213, v6, v6
  v_mov_b32 v5, v212
  s_nop 1
  v_permlane16_swap_b32 v212, v5
  s_nop 0
  v_add_f32 v212, v212, v5
  v_mov_b32 v5, v213
  s_nop 1
  v_permlane16_swap_b32 v213, v5
  s_nop 0
  v_add_f32 v213, v213, v5
  s_nop 1
  v_add_f32_dpp v212, v212, v212 row_ror:8 row_mask:0xf bank_mask:0xf
  v_add_f32_dpp v213, v213, v213 row_ror:8 row_mask:0xf bank_mask:0xf
  s_nop 1
  v_add_f32_dpp v212, v212, v212 row_ror:4 row_mask:0xf bank_mask:0xf
  v_add_f32_dpp v213, v213, v213 row_ror:4 row_mask:0xf bank_mask:0xf
  s_nop 1
  v_add_f32_dpp v212, v212, v212 row_ror:2 row_mask:0xf bank_mask:0xf
  v_add_f32_dpp v213, v213, v213 row_ror:2 row_mask:0xf bank_mask:0xf
  s_nop 1
  v_add_f32_dpp v212, v212, v212 row_ror:1 row_mask:0xf bank_mask:0xf
  v_add_f32_dpp v213, v213, v213 row_ror:1 row_mask:0xf bank_mask:0xf
  s_waitcnt vmcnt(3)
  s_mov_b32 s86, 0
L_tag_4:
  v_readfirstlane_b32 s90, v8
  v_readfirstlane_b32 s91, v9
  s_add_u32 s86, s86, 1
  s_cmp_lg_u32 s90, 0
  s_cbranch_scc1 L_tagd_5
  s_cmp_ge_u32 s86, 0x40000
  s_cbranch_scc1 L_tagd_5
  s_sleep 2
  v_mov_b32 v4, 0
  buffer_load_dwordx2 v[8:9], v4, s[24:27], 0 offen sc1
  s_waitcnt vmcnt(0)
  s_branch L_tag_4
L_tagd_5:
  v_mov_b32 v214, s90
  v_mov_b32 v215, s91
  s_mov_b32 exec_lo, 1
  s_mov_b32 exec_hi, 1
  buffer_store_dwordx4 v[212:215], v231, s[12:15], s42 offen sc1
  s_mov_b64 exec, -1
L_nopf_3:
  s_cmp_eq_u32 s22, 15
  s_cbranch_scc1 L_p1b_6
  s_lshl_b32 s28, s21, 7
  s_mov_b32 s38, s22
  s_lshl_b32 s29, s22, 7
  s_mov_b32 s77, -131072
  s_mov_b32 s36, 0
  s_mov_b32 s30, 0
  s_cmp_ge_u32 s20, 4
  s_cbranch_scc1 L_p1_ld_8
  s_lshr_b32 s74, s23, 1
  s_and_b32 s75, s23, 1
  v_lshrrev_b32 v4, 1, v3
  v_xor_b32 v4, v4, v2
  v_lshlrev_b32 v4, 4, v4
  v_lshl_add_u32 v28, v3, 7, v4
  s_mul_i32 s39, s74, 8192
  v_add_u32 v28, s39, v28
  v_xor_b32 v29, 64, v28
  s_mul_i32 s39, s75, 4096
  v_sub_u32 v30, v28, s39
  v_add_u32 v28, s39, v28
  v_sub_u32 v31, v29, s39
  v_add_u32 v29, s39, v29
  v_lshrrev_b32 v4, 2, v3
  v_and_b32 v5, 3, v3
  v_and_b32 v6, 1, v2
  v_lshl_add_u32 v6, v6, 2, v4
  v_lshl_add_u32 v4, v2, 3, v4
  v_lshlrev_b32 v4, 8, v4
  v_lshl_add_u32 v4, v5, 3, v4
  v_add_u32 v4, 16384, v4
  s_lshl_b32 s39, s74, 1
  s_add_u32 s39, s39, 0
  s_and_b32 s39, s39, 3
  s_lshl_b32 s40, s75, 2
  s_add_u32 s39, s39, s40
  v_xor_b32 v32, s39, v6
  v_lshl_add_u32 v32, v32, 5, v4
  s_lshl_b32 s39, s74, 1
  s_add_u32 s39, s39, 1
  s_and_b32 s39, s39, 3
  s_lshl_b32 s40, s75, 2
  s_add_u32 s39, s39, s40
  v_xor_b32 v33, s39, v6
  v_lshl_add_u32 v33, v33, 5, v4
  s_lshl_b32 s39, s74, 1
  s_add_u32 s39, s39, 2
  s_and_b32 s39, s39, 3
  s_lshl_b32 s40, s75, 2
  s_add_u32 s39, s39, s40
  v_xor_b32 v34, s39, v6
  v_lshl_add_u32 v34, v34, 5, v4
  s_lshl_b32 s39, s74, 1
  s_add_u32 s39, s39, 3
  s_and_b32 s39, s39, 3
  s_lshl_b32 s40, s75, 2
  s_add_u32 s39, s39, s40
  v_xor_b32 v35, s39, v6
  v_lshl_add_u32 v35, v35, 5, v4
  v_mov_b32 v36, 0
  v_mov_b32 v37, 0
  v_mov_b32 v38, 0
  v_mov_b32 v39, 0
  v_mov_b32 v40, 0
  v_mov_b32 v41, 0
  v_mov_b32 v42, 0
  v_mov_b32 v43, 0
  v_mov_b32 v44, 0
  v_mov_b32 v45, 0
  v_mov_b32 v46, 0
  v_mov_b32 v47, 0
  v_mov_b32 v48, 0
  v_mov_b32 v49, 0
  v_mov_b32 v50, 0
  v_mov_b32 v51, 0
  v_mov_b32 v52, 0
  v_mov_b32 v53, 0
  v_mov_b32 v54, 0
  v_mov_b32 v55, 0
  v_mov_b32 v56, 0
  v_mov_b32 v57, 0
  v_mov_b32 v58, 0
  v_mov_b32 v59, 0
  v_mov_b32 v60, 0
  v_mov_b32 v61, 0
  v_mov_b32 v62, 0
  v_mov_b32 v63, 0
  v_mov_b32 v64, 0
  v_mov_b32 v65, 0
  v_mov_b32 v66, 0
  v_mov_b32 v67, 0
  v_mov_b32 v68, 0
  v_mov_b32 v69, 0
  v_mov_b32 v70, 0
  v_mov_b32 v71, 0
  v_mov_b32 v72, 0
  v_mov_b32 v73, 0
  v_mov_b32 v74, 0
  v_mov_b32 v75, 0
  v_mov_b32 v76, 0
  v_mov_b32 v77, 0
  v_mov_b32 v78, 0
  v_mov_b32 v79, 0
  v_mov_b32 v80, 0
  v_mov_b32 v81, 0
  v_mov_b32 v82, 0
  v_mov_b32 v83, 0
  v_mov_b32 v84, 0
  v_mov_b32 v85, 0
  v_mov_b32 v86, 0
  v_mov_b32 v87, 0
  v_mov_b32 v88, 0
  v_mov_b32 v89, 0
  v_mov_b32 v90, 0
  v_mov_b32 v91, 0
  v_mov_b32 v92, 0
  v_mov_b32 v93, 0
  v_mov_b32 v94, 0
  v_mov_b32 v95, 0
  v_mov_b32 v96, 0
  v_mov_b32 v97, 0
  v_mov_b32 v98, 0
  v_mov_b32 v99, 0
  v_mov_b32 v228, 0x3f803f80
  v_mov_b32 v229, 0x3f803f80
  v_mov_b32 v230, 0x3f803f80
  v_mov_b32 v231, 0x3f803f80
  v_mov_b32 v232, 0
  v_mov_b32 v233, 0
  v_mov_b32 v234, 0
  v_mov_b32 v235, 0
  v_mov_b32 v236, 0
  v_mov_b32 v237, 0
  v_mov_b32 v238, 0
  v_mov_b32 v239, 0
  s_mov_b32 s12, s60
  s_and_b32 s13, s61, 0xffff
  s_mov_b32 s14, 0x780000
  s_mov_b32 s15, 0x20000
  s_barrier
  ds_read_b64_tr_b16 v[164:165], v32 offset:0
  ds_read_b64_tr_b16 v[166:167], v32 offset:1024
  ds_read_b64_tr_b16 v[168:169], v33 offset:0
  ds_read_b64_tr_b16 v[170:171], v33 offset:1024
  ds_read_b64_tr_b16 v[172:173], v34 offset:0
  ds_read_b64_tr_b16 v[174:175], v34 offset:1024
  ds_read_b64_tr_b16 v[176:177], v35 offset:0
  ds_read_b64_tr_b16 v[178:179], v35 offset:1024
  ds_read_b128 v[100:103], v28 offset:0
  ds_read_b128 v[104:107], v28 offset:2048
  ds_read_b128 v[108:111], v30 offset:4096
  ds_read_b128 v[112:115], v30 offset:6144
  ds_read_b64_tr_b16 v[180:181], v32 offset:8192
  ds_read_b64_tr_b16 v[182:183], v32 offset:9216
  ds_read_b64_tr_b16 v[184:185], v33 offset:8192
  ds_read_b64_tr_b16 v[186:187], v33 offset:9216
  ds_read_b64_tr_b16 v[188:189], v34 offset:8192
  ds_read_b64_tr_b16 v[190:191], v34 offset:9216
  ds_read_b64_tr_b16 v[192:193], v35 offset:8192
  ds_read_b64_tr_b16 v[194:195], v35 offset:9216
  ds_read_b128 v[116:119], v29 offset:0
  ds_read_b128 v[120:123], v29 offset:2048
  ds_read_b128 v[124:127], v31 offset:4096
  ds_read_b128 v[128:131], v31 offset:6144
L_p1_loop_10:
  s_barrier
  s_add_u32 s36, s36, 1
  s_cmp_eq_u32 s36, 5
  s_cselect_b32 s35, s77, 32768
  s_cselect_b32 s36, 0, s36
  v_add_u32 v28, s35, v28
  v_add_u32 v30, s35, v30
  v_add_u32 v29, s35, v29
  v_add_u32 v31, s35, v31
  v_add_u32 v32, s35, v32
  v_add_u32 v33, s35, v33
  v_add_u32 v34, s35, v34
  v_add_u32 v35, s35, v35
  s_waitcnt lgkmcnt(0)
  ds_read_b64_tr_b16 v[196:197], v32 offset:0
  ds_read_b64_tr_b16 v[198:199], v32 offset:1024
  v_mfma_f32_16x16x32_bf16 v[36:39], v[164:167], v[100:103], v[36:39]
  ds_read_b64_tr_b16 v[200:201], v33 offset:0
  ds_read_b64_tr_b16 v[202:203], v33 offset:1024
  v_mfma_f32_16x16x32_bf16 v[40:43], v[168:171], v[100:103], v[40:43]
  ds_read_b64_tr_b16 v[204:205], v34 offset:0
  ds_read_b64_tr_b16 v[206:207], v34 offset:1024
  v_mfma_f32_16x16x32_bf16 v[44:47], v[172:175], v[100:103], v[44:47]
  ds_read_b64_tr_b16 v[208:209], v35 offset:0
  ds_read_b64_tr_b16 v[210:211], v35 offset:1024
  v_mfma_f32_16x16x32_bf16 v[48:51], v[176:179], v[100:103], v[48:51]
  ds_read_b128 v[132:135], v28 offset:0
  ds_read_b128 v[136:139], v28 offset:2048
  v_mfma_f32_16x16x32_bf16 v[52:55], v[164:167], v[104:107], v[52:55]
  ds_read_b128 v[140:143], v30 offset:4096
  ds_read_b128 v[144:147], v30 offset:6144
  v_mfma_f32_16x16x32_bf16 v[56:59], v[168:171], v[104:107], v[56:59]
  ds_read_b64_tr_b16 v[212:213], v32 offset:8192
  ds_read_b64_tr_b16 v[214:215], v32 offset:9216
  v_mfma_f32_16x16x32_bf16 v[60:63], v[172:175], v[104:107], v[60:63]
  ds_read_b64_tr_b16 v[216:217], v33 offset:8192
  ds_read_b64_tr_b16 v[218:219], v33 offset:9216
  v_mfma_f32_16x16x32_bf16 v[64:67], v[176:179], v[104:107], v[64:67]
  ds_read_b64_tr_b16 v[220:221], v34 offset:8192
  ds_read_b64_tr_b16 v[222:223], v34 offset:9216
  v_mfma_f32_16x16x32_bf16 v[68:71], v[164:167], v[108:111], v[68:71]
  ds_read_b64_tr_b16 v[224:225], v35 offset:8192
  ds_read_b64_tr_b16 v[226:227], v35 offset:9216
  v_mfma_f32_16x16x32_bf16 v[72:75], v[168:171], v[108:111], v[72:75]
  ds_read_b128 v[148:151], v29 offset:0
  ds_read_b128 v[152:155], v29 offset:2048
  v_mfma_f32_16x16x32_bf16 v[76:79], v[172:175], v[108:111], v[76:79]
  ds_read_b128 v[156:159], v31 offset:4096
  ds_read_b128 v[160:163], v31 offset:6144
  v_mfma_f32_16x16x32_bf16 v[80:83], v[176:179], v[108:111], v[80:83]
  v_mfma_f32_16x16x32_bf16 v[84:87], v[164:167], v[112:115], v[84:87]
  v_mfma_f32_16x16x32_bf16 v[88:91], v[168:171], v[112:115], v[88:91]
  v_mfma_f32_16x16x32_bf16 v[92:95], v[172:175], v[112:115], v[92:95]
  v_mfma_f32_16x16x32_bf16 v[96:99], v[176:179], v[112:115], v[96:99]
  v_mfma_f32_16x16x32_bf16 v[232:235], v[164:167], v[228:231], v[232:235]
  v_mfma_f32_16x16x32_bf16 v[236:239], v[168:171], v[228:231], v[236:239]
  v_mfma_f32_16x16x32_bf16 v[36:39], v[180:183], v[116:119], v[36:39]
  v_mfma_f32_16x16x32_bf16 v[40:43], v[184:187], v[116:119], v[40:43]
  v_mfma_f32_16x16x32_bf16 v[44:47], v[188:191], v[116:119], v[44:47]
  v_mfma_f32_16x16x32_bf16 v[48:51], v[192:195], v[116:119], v[48:51]
  v_mfma_f32_16x16x32_bf16 v[52:55], v[180:183], v[120:123], v[52:55]
  v_mfma_f32_16x16x32_bf16 v[56:59], v[184:187], v[120:123], v[56:59]
  v_mfma_f32_16x16x32_bf16 v[60:63], v[188:191], v[120:123], v[60:63]
  v_mfma_f32_16x16x32_bf16 v[64:67], v[192:195], v[120:123], v[64:67]
  v_mfma_f32_16x16x32_bf16 v[68:71], v[180:183], v[124:127], v[68:71]
  v_mfma_f32_16x16x32_bf16 v[72:75], v[184:187], v[124:127], v[72:75]
  v_mfma_f32_16x16x32_bf16 v[76:79], v[188:191], v[124:127], v[76:79]
  v_mfma_f32_16x16x32_bf16 v[80:83], v[192:195], v[124:127], v[80:83]
  v_mfma_f32_16x16x32_bf16 v[84:87], v[180:183], v[128:131], v[84:87]
  v_mfma_f32_16x16x32_bf16 v[88:91], v[184:187], v[128:131], v[88:91]
  v_mfma_f32_16x16x32_bf16 v[92:95], v[188:191], v[128:131], v[92:95]
  v_mfma_f32_16x16x32_bf16 v[96:99], v[192:195], v[128:131], v[96:99]
  v_mfma_f32_16x16x32_bf16 v[232:235], v[180:183], v[228:231], v[232:235]
  v_mfma_f32_16x16x32_bf16 v[236:239], v[184:187], v[228:231], v[236:239]
  s_barrier
  s_add_u32 s36, s36, 1
  s_cmp_eq_u32 s36, 5
  s_cselect_b32 s35, s77, 32768
  s_cselect_b32 s36, 0, s36
  v_add_u32 v28, s35, v28
  v_add_u32 v30, s35, v30
  v_add_u32 v29, s35, v29
  v_add_u32 v31, s35, v31
  v_add_u32 v32, s35, v32
  v_add_u32 v33, s35, v33
  v_add_u32 v34, s35, v34
  v_add_u32 v35, s35, v35
  s_waitcnt lgkmcnt(0)
  ds_read_b64_tr_b16 v[164:165], v32 offset:0
  ds_read_b64_tr_b16 v[166:167], v32 offset:1024
  v_mfma_f32_16x16x32_bf16 v[36:39], v[196:199], v[132:135], v[36:39]
  ds_read_b64_tr_b16 v[168:169], v33 offset:0
  ds_read_b64_tr_b16 v[170:171], v33 offset:1024
  v_mfma_f32_16x16x32_bf16 v[40:43], v[200:203], v[132:135], v[40:43]
  ds_read_b64_tr_b16 v[172:173], v34 offset:0
  ds_read_b64_tr_b16 v[174:175], v34 offset:1024
  v_mfma_f32_16x16x32_bf16 v[44:47], v[204:207], v[132:135], v[44:47]
  ds_read_b64_tr_b16 v[176:177], v35 offset:0
  ds_read_b64_tr_b16 v[178:179], v35 offset:1024
  v_mfma_f32_16x16x32_bf16 v[48:51], v[208:211], v[132:135], v[48:51]
  ds_read_b128 v[100:103], v28 offset:0
  ds_read_b128 v[104:107], v28 offset:2048
  v_mfma_f32_16x16x32_bf16 v[52:55], v[196:199], v[136:139], v[52:55]
  ds_read_b128 v[108:111], v30 offset:4096
  ds_read_b128 v[112:115], v30 offset:6144
  v_mfma_f32_16x16x32_bf16 v[56:59], v[200:203], v[136:139], v[56:59]
  ds_read_b64_tr_b16 v[180:181], v32 offset:8192
  ds_read_b64_tr_b16 v[182:183], v32 offset:9216
  v_mfma_f32_16x16x32_bf16 v[60:63], v[204:207], v[136:139], v[60:63]
  ds_read_b64_tr_b16 v[184:185], v33 offset:8192
  ds_read_b64_tr_b16 v[186:187], v33 offset:9216
  v_mfma_f32_16x16x32_bf16 v[64:67], v[208:211], v[136:139], v[64:67]
  ds_read_b64_tr_b16 v[188:189], v34 offset:8192
  ds_read_b64_tr_b16 v[190:191], v34 offset:9216
  v_mfma_f32_16x16x32_bf16 v[68:71], v[196:199], v[140:143], v[68:71]
  ds_read_b64_tr_b16 v[192:193], v35 offset:8192
  ds_read_b64_tr_b16 v[194:195], v35 offset:9216
  v_mfma_f32_16x16x32_bf16 v[72:75], v[200:203], v[140:143], v[72:75]
  ds_read_b128 v[116:119], v29 offset:0
  ds_read_b128 v[120:123], v29 offset:2048
  v_mfma_f32_16x16x32_bf16 v[76:79], v[204:207], v[140:143], v[76:79]
  ds_read_b128 v[124:127], v31 offset:4096
  ds_read_b128 v[128:131], v31 offset:6144
  v_mfma_f32_16x16x32_bf16 v[80:83], v[208:211], v[140:143], v[80:83]
  v_mfma_f32_16x16x32_bf16 v[84:87], v[196:199], v[144:147], v[84:87]
  v_mfma_f32_16x16x32_bf16 v[88:91], v[200:203], v[144:147], v[88:91]
  v_mfma_f32_16x16x32_bf16 v[92:95], v[204:207], v[144:147], v[92:95]
  v_mfma_f32_16x16x32_bf16 v[96:99], v[208:211], v[144:147], v[96:99]
  v_mfma_f32_16x16x32_bf16 v[232:235], v[196:199], v[228:231], v[232:235]
  v_mfma_f32_16x16x32_bf16 v[236:239], v[200:203], v[228:231], v[236:239]
  v_mfma_f32_16x16x32_bf16 v[36:39], v[212:215], v[148:151], v[36:39]
  v_mfma_f32_16x16x32_bf16 v[40:43], v[216:219], v[148:151], v[40:43]
  v_mfma_f32_16x16x32_bf16 v[44:47], v[220:223], v[148:151], v[44:47]
  v_mfma_f32_16x16x32_bf16 v[48:51], v[224:227], v[148:151], v[48:51]
  v_mfma_f32_16x16x32_bf16 v[52:55], v[212:215], v[152:155], v[52:55]
  v_mfma_f32_16x16x32_bf16 v[56:59], v[216:219], v[152:155], v[56:59]
  v_mfma_f32_16x16x32_bf16 v[60:63], v[220:223], v[152:155], v[60:63]
  v_mfma_f32_16x16x32_bf16 v[64:67], v[224:227], v[152:155], v[64:67]
  v_mfma_f32_16x16x32_bf16 v[68:71], v[212:215], v[156:159], v[68:71]
  v_mfma_f32_16x16x32_bf16 v[72:75], v[216:219], v[156:159], v[72:75]
  v_mfma_f32_16x16x32_bf16 v[76:79], v[220:223], v[156:159], v[76:79]
  v_mfma_f32_16x16x32_bf16 v[80:83], v[224:227], v[156:159], v[80:83]
  v_mfma_f32_16x16x32_bf16 v[84:87], v[212:215], v[160:163], v[84:87]
  v_mfma_f32_16x16x32_bf16 v[88:91], v[216:219], v[160:163], v[88:91]
  v_mfma_f32_16x16x32_bf16 v[92:95], v[220:223], v[160:163], v[92:95]
  v_mfma_f32_16x16x32_bf16 v[96:99], v[224:227], v[160:163], v[96:99]
  v_mfma_f32_16x16x32_bf16 v[232:235], v[212:215], v[228:231], v[232:235]
  v_mfma_f32_16x16x32_bf16 v[236:239], v[216:219], v[228:231], v[236:239]
  s_add_u32 s30, s30, 1
  s_cmp_lt_u32 s30, 4
  s_cbranch_scc1 L_p1_loop_10
  s_barrier
  s_add_u32 s36, s36, 1
  s_cmp_eq_u32 s36, 5
  s_cselect_b32 s35, s77, 32768
  s_cselect_b32 s36, 0, s36
  v_add_u32 v28, s35, v28
  v_add_u32 v30, s35, v30
  v_add_u32 v29, s35, v29
  v_add_u32 v31, s35, v31
  v_add_u32 v32, s35, v32
  v_add_u32 v33, s35, v33
  v_add_u32 v34, s35, v34
  v_add_u32 v35, s35, v35
  s_waitcnt lgkmcnt(0)
  ds_read_b64_tr_b16 v[196:197], v32 offset:0
  ds_read_b64_tr_b16 v[198:199], v32 offset:1024
  v_mfma_f32_16x16x32_bf16 v[36:39], v[164:167], v[100:103], v[36:39]
  ds_read_b64_tr_b16 v[200:201], v33 offset:0
  ds_read_b64_tr_b16 v[202:203], v33 offset:1024
  v_mfma_f32_16x16x32_bf16 v[40:43], v[168:171], v[100:103], v[40:43]
  ds_read_b64_tr_b16 v[204:205], v34 offset:0
  ds_read_b64_tr_b16 v[206:207], v34 offset:1024
  v_mfma_f32_16x16x32_bf16 v[44:47], v[172:175], v[100:103], v[44:47]
  ds_read_b64_tr_b16 v[208:209], v35 offset:0
  ds_read_b64_tr_b16 v[210:211], v35 offset:1024
  v_mfma_f32_16x16x32_bf16 v[48:51], v[176:179], v[100:103], v[48:51]
  ds_read_b128 v[132:135], v28 offset:0
  ds_read_b128 v[136:139], v28 offset:2048
  v_mfma_f32_16x16x32_bf16 v[52:55], v[164:167], v[104:107], v[52:55]
  ds_read_b128 v[140:143], v30 offset:4096
  ds_read_b128 v[144:147], v30 offset:6144
  v_mfma_f32_16x16x32_bf16 v[56:59], v[168:171], v[104:107], v[56:59]
  ds_read_b64_tr_b16 v[212:213], v32 offset:8192
  ds_read_b64_tr_b16 v[214:215], v32 offset:9216
  v_mfma_f32_16x16x32_bf16 v[60:63], v[172:175], v[104:107], v[60:63]
  ds_read_b64_tr_b16 v[216:217], v33 offset:8192
  ds_read_b64_tr_b16 v[218:219], v33 offset:9216
  v_mfma_f32_16x16x32_bf16 v[64:67], v[176:179], v[104:107], v[64:67]
  ds_read_b64_tr_b16 v[220:221], v34 offset:8192
  ds_read_b64_tr_b16 v[222:223], v34 offset:9216
  v_mfma_f32_16x16x32_bf16 v[68:71], v[164:167], v[108:111], v[68:71]
  ds_read_b64_tr_b16 v[224:225], v35 offset:8192
  ds_read_b64_tr_b16 v[226:227], v35 offset:9216
  v_mfma_f32_16x16x32_bf16 v[72:75], v[168:171], v[108:111], v[72:75]
  ds_read_b128 v[148:151], v29 offset:0
  ds_read_b128 v[152:155], v29 offset:2048
  v_mfma_f32_16x16x32_bf16 v[76:79], v[172:175], v[108:111], v[76:79]
  ds_read_b128 v[156:159], v31 offset:4096
  ds_read_b128 v[160:163], v31 offset:6144
  v_mfma_f32_16x16x32_bf16 v[80:83], v[176:179], v[108:111], v[80:83]
  v_mfma_f32_16x16x32_bf16 v[84:87], v[164:167], v[112:115], v[84:87]
  v_mfma_f32_16x16x32_bf16 v[88:91], v[168:171], v[112:115], v[88:91]
  v_mfma_f32_16x16x32_bf16 v[92:95], v[172:175], v[112:115], v[92:95]
  v_mfma_f32_16x16x32_bf16 v[96:99], v[176:179], v[112:115], v[96:99]
  v_mfma_f32_16x16x32_bf16 v[232:235], v[164:167], v[228:231], v[232:235]
  v_mfma_f32_16x16x32_bf16 v[236:239], v[168:171], v[228:231], v[236:239]
  v_mfma_f32_16x16x32_bf16 v[36:39], v[180:183], v[116:119], v[36:39]
  v_mfma_f32_16x16x32_bf16 v[40:43], v[184:187], v[116:119], v[40:43]
  v_mfma_f32_16x16x32_bf16 v[44:47], v[188:191], v[116:119], v[44:47]
  v_mfma_f32_16x16x32_bf16 v[48:51], v[192:195], v[116:119], v[48:51]
  v_mfma_f32_16x16x32_bf16 v[52:55], v[180:183], v[120:123], v[52:55]
  v_mfma_f32_16x16x32_bf16 v[56:59], v[184:187], v[120:123], v[56:59]
  v_mfma_f32_16x16x32_bf16 v[60:63], v[188:191], v[120:123], v[60:63]
  v_mfma_f32_16x16x32_bf16 v[64:67], v[192:195], v[120:123], v[64:67]
  v_mfma_f32_16x16x32_bf16 v[68:71], v[180:183], v[124:127], v[68:71]
  v_mfma_f32_16x16x32_bf16 v[72:75], v[184:187], v[124:127], v[72:75]
  v_mfma_f32_16x16x32_bf16 v[76:79], v[188:191], v[124:127], v[76:79]
  v_mfma_f32_16x16x32_bf16 v[80:83], v[192:195], v[124:127], v[80:83]
  v_mfma_f32_16x16x32_bf16 v[84:87], v[180:183], v[128:131], v[84:87]
  v_mfma_f32_16x16x32_bf16 v[88:91], v[184:187], v[128:131], v[88:91]
  v_mfma_f32_16x16x32_bf16 v[92:95], v[188:191], v[128:131], v[92:95]
  v_mfma_f32_16x16x32_bf16 v[96:99], v[192:195], v[128:131], v[96:99]
  v_mfma_f32_16x16x32_bf16 v[232:235], v[180:183], v[228:231], v[232:235]
  v_mfma_f32_16x16x32_bf16 v[236:239], v[184:187], v[228:231], v[236:239]
  s_waitcnt lgkmcnt(0)
  v_mfma_f32_16x16x32_bf16 v[36:39], v[196:199], v[132:135], v[36:39]
  v_mfma_f32_16x16x32_bf16 v[40:43], v[200:203], v[132:135], v[40:43]
  v_mfma_f32_16x16x32_bf16 v[44:47], v[204:207], v[132:135], v[44:47]
  v_mfma_f32_16x16x32_bf16 v[48:51], v[208:211], v[132:135], v[48:51]
  v_mfma_f32_16x16x32_bf16 v[52:55], v[196:199], v[136:139], v[52:55]
  v_mfma_f32_16x16x32_bf16 v[56:59], v[200:203], v[136:139], v[56:59]
  v_mfma_f32_16x16x32_bf16 v[60:63], v[204:207], v[136:139], v[60:63]
  v_mfma_f32_16x16x32_bf16 v[64:67], v[208:211], v[136:139], v[64:67]
  v_mfma_f32_16x16x32_bf16 v[68:71], v[196:199], v[140:143], v[68:71]
  v_mfma_f32_16x16x32_bf16 v[72:75], v[200:203], v[140:143], v[72:75]
  v_mfma_f32_16x16x32_bf16 v[76:79], v[204:207], v[140:143], v[76:79]
  v_mfma_f32_16x16x32_bf16 v[80:83], v[208:211], v[140:143], v[80:83]
  v_mfma_f32_16x16x32_bf16 v[84:87], v[196:199], v[144:147], v[84:87]
  v_mfma_f32_16x16x32_bf16 v[88:91], v[200:203], v[144:147], v[88:91]
  v_mfma_f32_16x16x32_bf16 v[92:95], v[204:207], v[144:147], v[92:95]
  v_mfma_f32_16x16x32_bf16 v[96:99], v[208:211], v[144:147], v[96:99]
  v_mfma_f32_16x16x32_bf16 v[232:235], v[196:199], v[228:231], v[232:235]
  v_mfma_f32_16x16x32_bf16 v[236:239], v[200:203], v[228:231], v[236:239]
  v_mfma_f32_16x16x32_bf16 v[36:39], v[212:215], v[148:151], v[36:39]
  v_mfma_f32_16x16x32_bf16 v[40:43], v[216:219], v[148:151], v[40:43]
  v_mfma_f32_16x16x32_bf16 v[44:47], v[220:223], v[148:151], v[44:47]
  v_mfma_f32_16x16x32_bf16 v[48:51], v[224:227], v[148:151], v[48:51]
  v_mfma_f32_16x16x32_bf16 v[52:55], v[212:215], v[152:155], v[52:55]
  v_mfma_f32_16x16x32_bf16 v[56:59], v[216:219], v[152:155], v[56:59]
  v_mfma_f32_16x16x32_bf16 v[60:63], v[220:223], v[152:155], v[60:63]
  v_mfma_f32_16x16x32_bf16 v[64:67], v[224:227], v[152:155], v[64:67]
  v_mfma_f32_16x16x32_bf16 v[68:71], v[212:215], v[156:159], v[68:71]
  v_mfma_f32_16x16x32_bf16 v[72:75], v[216:219], v[156:159], v[72:75]
  v_mfma_f32_16x16x32_bf16 v[76:79], v[220:223], v[156:159], v[76:79]
  v_mfma_f32_16x16x32_bf16 v[80:83], v[224:227], v[156:159], v[80:83]
  v_mfma_f32_16x16x32_bf16 v[84:87], v[212:215], v[160:163], v[84:87]
  v_mfma_f32_16x16x32_bf16 v[88:91], v[216:219], v[160:163], v[88:91]
  v_mfma_f32_16x16x32_bf16 v[92:95], v[220:223], v[160:163], v[92:95]
  v_mfma_f32_16x16x32_bf16 v[96:99], v[224:227], v[160:163], v[96:99]
  v_mfma_f32_16x16x32_bf16 v[232:235], v[212:215], v[228:231], v[232:235]
  v_mfma_f32_16x16x32_bf16 v[236:239], v[216:219], v[228:231], v[236:239]
  s_nop 7
  s_lshl_b32 s39, s74, 6
  s_lshl_b32 s40, s75, 5
  s_add_u32 s39, s39, s40
  v_add_u32 v4, s39, v3
  v_lshlrev_b32 v4, 3, v4
  v_add_u32 v140, 65536, v4
  s_lshl_b32 s39, s75, 8
  s_lshl_b32 s40, s74, 7
  s_add_u32 s41, s39, s40
  s_sub_u32 s39, s39, s40
  v_lshlrev_b32 v5, 4, v2
  v_add_u32 v5, 66560, v5
  v_add_u32 v6, s39, v5
  v_add_u32 v5, s41, v5
  ds_write_b128 v5, v[232:235]
  ds_write_b128 v5, v[236:239] offset:64
  s_lshl_b32 s39, s75, 9
  v_sub_u32 v5, v140, s39
  s_waitcnt lgkmcnt(0)
  s_barrier
  ds_read_b64 v[100:101], v140 offset:0
  ds_read_b64 v[102:103], v140 offset:128
  ds_read_b64 v[104:105], v5 offset:256
  ds_read_b64 v[106:107], v5 offset:384
  ds_read_b128 v[132:135], v6 offset:128
  ds_read_b128 v[136:139], v6 offset:192
  s_cmp_lt_u32 s38, 5
  s_cselect_b32 s76, 0x3ea52b5c, 1.0
  s_mov_b32 s39, 0x3acccccd
  s_mov_b32 s40, 0x3727c5ac
  v_and_b32 v4, 1, v2
  v_lshlrev_b32 v4, 1, v4
  v_lshrrev_b32 v5, 1, v2
  v_add_u32 v4, v4, v5
  v_mul_u32_u24 v4, 32768, v4
  v_lshl_add_u32 v4, v3, 4, v4
  s_lshl_b32 s86, s74, 6
  s_add_u32 s86, s86, s28
  s_lshl_b32 s86, s86, 4
  s_lshl_b32 s87, s75, 9
  s_add_u32 s88, s86, s87
  s_sub_u32 s86, s86, s87
  v_add_u32 v140, s88, v4
  v_add_u32 v140, 0, v140
  v_add_u32 v141, s88, v4
  v_add_u32 v141, 256, v141
  v_add_u32 v142, s86, v4
  v_add_u32 v142, 512, v142
  v_add_u32 v143, s86, v4
  v_add_u32 v143, 768, v143
  s_lshr_b32 s86, s29, 3
  s_lshl_b32 s87, s75, 3
  s_add_u32 s86, s86, s87
  s_lshl_b32 s87, s74, 2
  s_add_u32 s70, s86, s87
  s_mul_i32 s70, s70, 32768
  s_sub_u32 s71, s86, s87
  s_add_u32 s71, s71, 4
  s_mul_i32 s71, s71, 32768
  s_waitcnt lgkmcnt(4)
  v_mul_f32 v100, s39, v100
  v_mul_f32 v101, s39, v101
  v_fma_f32 v101, -v100, v100, v101
  v_max_f32 v101, 0, v101
  v_add_f32 v101, s40, v101
  v_rsq_f32 v116, v101
  v_sub_f32 v108, 0, v100
  v_mul_f32 v116, s76, v116
  v_mul_f32 v102, s39, v102
  v_mul_f32 v103, s39, v103
  v_fma_f32 v103, -v102, v102, v103
  v_max_f32 v103, 0, v103
  v_add_f32 v103, s40, v103
  v_rsq_f32 v118, v103
  v_sub_f32 v110, 0, v102
  v_mul_f32 v118, s76, v118
  v_pk_fma_f32 v[36:37], v[232:233], v[108:109], v[36:37] op_sel_hi:[1,0,1]
  v_pk_fma_f32 v[38:39], v[234:235], v[108:109], v[38:39] op_sel_hi:[1,0,1]
  v_pk_mul_f32 v[36:37], v[36:37], v[116:117] op_sel_hi:[1,0]
  v_pk_mul_f32 v[38:39], v[38:39], v[116:117] op_sel_hi:[1,0]
  v_cvt_pk_bf16_f32 v144, v36, v37
  v_cvt_pk_bf16_f32 v145, v38, v39
  v_pk_fma_f32 v[40:41], v[236:237], v[108:109], v[40:41] op_sel_hi:[1,0,1]
  v_pk_fma_f32 v[42:43], v[238:239], v[108:109], v[42:43] op_sel_hi:[1,0,1]
  v_pk_mul_f32 v[40:41], v[40:41], v[116:117] op_sel_hi:[1,0]
  v_pk_mul_f32 v[42:43], v[42:43], v[116:117] op_sel_hi:[1,0]
  v_cvt_pk_bf16_f32 v146, v40, v41
  v_cvt_pk_bf16_f32 v147, v42, v43
  s_nop 1
  v_permlane16_swap_b32 v144, v146
  v_permlane16_swap_b32 v145, v147
  buffer_store_dwordx4 v[144:147], v140, s[12:15], s70 offen sc1
  v_pk_fma_f32 v[52:53], v[232:233], v[110:111], v[52:53] op_sel_hi:[1,0,1]
  v_pk_fma_f32 v[54:55], v[234:235], v[110:111], v[54:55] op_sel_hi:[1,0,1]
  v_pk_mul_f32 v[52:53], v[52:53], v[118:119] op_sel_hi:[1,0]
  v_pk_mul_f32 v[54:55], v[54:55], v[118:119] op_sel_hi:[1,0]
  v_cvt_pk_bf16_f32 v148, v52, v53
  v_cvt_pk_bf16_f32 v149, v54, v55
  v_pk_fma_f32 v[56:57], v[236:237], v[110:111], v[56:57] op_sel_hi:[1,0,1]
  v_pk_fma_f32 v[58:59], v[238:239], v[110:111], v[58:59] op_sel_hi:[1,0,1]
  v_pk_mul_f32 v[56:57], v[56:57], v[118:119] op_sel_hi:[1,0]
  v_pk_mul_f32 v[58:59], v[58:59], v[118:119] op_sel_hi:[1,0]
  v_cvt_pk_bf16_f32 v150, v56, v57
  v_cvt_pk_bf16_f32 v151, v58, v59
  s_nop 1
  v_permlane16_swap_b32 v148, v150
  v_permlane16_swap_b32 v149, v151
  buffer_store_dwordx4 v[148:151], v141, s[12:15], s70 offen sc1
  s_waitcnt lgkmcnt(0)
  v_mul_f32 v104, s39, v104
  v_mul_f32 v105, s39, v105
  v_fma_f32 v105, -v104, v104, v105
  v_max_f32 v105, 0, v105
  v_add_f32 v105, s40, v105
  v_rsq_f32 v120, v105
  v_sub_f32 v112, 0, v104
  v_mul_f32 v120, s76, v120
  v_mul_f32 v106, s39, v106
  v_mul_f32 v107, s39, v107
  v_fma_f32 v107, -v106, v106, v107
  v_max_f32 v107, 0, v107
  v_add_f32 v107, s40, v107
  v_rsq_f32 v122, v107
  v_sub_f32 v114, 0, v106
  v_mul_f32 v122, s76, v122
  v_pk_fma_f32 v[44:45], v[132:133], v[108:109], v[44:45] op_sel_hi:[1,0,1]
  v_pk_fma_f32 v[46:47], v[134:135], v[108:109], v[46:47] op_sel_hi:[1,0,1]
  v_pk_mul_f32 v[44:45], v[44:45], v[116:117] op_sel_hi:[1,0]
  v_pk_mul_f32 v[46:47], v[46:47], v[116:117] op_sel_hi:[1,0]
  v_cvt_pk_bf16_f32 v144, v44, v45
  v_cvt_pk_bf16_f32 v145, v46, v47
  v_pk_fma_f32 v[48:49], v[136:137], v[108:109], v[48:49] op_sel_hi:[1,0,1]
  v_pk_fma_f32 v[50:51], v[138:139], v[108:109], v[50:51] op_sel_hi:[1,0,1]
  v_pk_mul_f32 v[48:49], v[48:49], v[116:117] op_sel_hi:[1,0]
  v_pk_mul_f32 v[50:51], v[50:51], v[116:117] op_sel_hi:[1,0]
  v_cvt_pk_bf16_f32 v146, v48, v49
  v_cvt_pk_bf16_f32 v147, v50, v51
  s_nop 1
  v_permlane16_swap_b32 v144, v146
  v_permlane16_swap_b32 v145, v147
  buffer_store_dwordx4 v[144:147], v140, s[12:15], s71 offen sc1
  v_pk_fma_f32 v[60:61], v[132:133], v[110:111], v[60:61] op_sel_hi:[1,0,1]
  v_pk_fma_f32 v[62:63], v[134:135], v[110:111], v[62:63] op_sel_hi:[1,0,1]
  v_pk_mul_f32 v[60:61], v[60:61], v[118:119] op_sel_hi:[1,0]
  v_pk_mul_f32 v[62:63], v[62:63], v[118:119] op_sel_hi:[1,0]
  v_cvt_pk_bf16_f32 v148, v60, v61
  v_cvt_pk_bf16_f32 v149, v62, v63
  v_pk_fma_f32 v[64:65], v[136:137], v[110:111], v[64:65] op_sel_hi:[1,0,1]
  v_pk_fma_f32 v[66:67], v[138:139], v[110:111], v[66:67] op_sel_hi:[1,0,1]
  v_pk_mul_f32 v[64:65], v[64:65], v[118:119] op_sel_hi:[1,0]
  v_pk_mul_f32 v[66:67], v[66:67], v[118:119] op_sel_hi:[1,0]
  v_cvt_pk_bf16_f32 v150, v64, v65
  v_cvt_pk_bf16_f32 v151, v66, v67
  s_nop 1
  v_permlane16_swap_b32 v148, v150
  v_permlane16_swap_b32 v149, v151
  buffer_store_dwordx4 v[148:151], v141, s[12:15], s71 offen sc1
  v_pk_fma_f32 v[68:69], v[232:233], v[112:113], v[68:69] op_sel_hi:[1,0,1]
  v_pk_fma_f32 v[70:71], v[234:235], v[112:113], v[70:71] op_sel_hi:[1,0,1]
  v_pk_mul_f32 v[68:69], v[68:69], v[120:121] op_sel_hi:[1,0]
  v_pk_mul_f32 v[70:71], v[70:71], v[120:121] op_sel_hi:[1,0]
  v_cvt_pk_bf16_f32 v144, v68, v69
  v_cvt_pk_bf16_f32 v145, v70, v71
  v_pk_fma_f32 v[72:73], v[236:237], v[112:113], v[72:73] op_sel_hi:[1,0,1]
  v_pk_fma_f32 v[74:75], v[238:239], v[112:113], v[74:75] op_sel_hi:[1,0,1]
  v_pk_mul_f32 v[72:73], v[72:73], v[120:121] op_sel_hi:[1,0]
  v_pk_mul_f32 v[74:75], v[74:75], v[120:121] op_sel_hi:[1,0]
  v_cvt_pk_bf16_f32 v146, v72, v73
  v_cvt_pk_bf16_f32 v147, v74, v75
  s_nop 1
  v_permlane16_swap_b32 v144, v146
  v_permlane16_swap_b32 v145, v147
  buffer_store_dwordx4 v[144:147], v142, s[12:15], s70 offen sc1
  v_pk_fma_f32 v[76:77], v[132:133], v[112:113], v[76:77] op_sel_hi:[1,0,1]
  v_pk_fma_f32 v[78:79], v[134:135], v[112:113], v[78:79] op_sel_hi:[1,0,1]
  v_pk_mul_f32 v[76:77], v[76:77], v[120:121] op_sel_hi:[1,0]
  v_pk_mul_f32 v[78:79], v[78:79], v[120:121] op_sel_hi:[1,0]
  v_cvt_pk_bf16_f32 v148, v76, v77
  v_cvt_pk_bf16_f32 v149, v78, v79
  v_pk_fma_f32 v[80:81], v[136:137], v[112:113], v[80:81] op_sel_hi:[1,0,1]
  v_pk_fma_f32 v[82:83], v[138:139], v[112:113], v[82:83] op_sel_hi:[1,0,1]
  v_pk_mul_f32 v[80:81], v[80:81], v[120:121] op_sel_hi:[1,0]
  v_pk_mul_f32 v[82:83], v[82:83], v[120:121] op_sel_hi:[1,0]
  v_cvt_pk_bf16_f32 v150, v80, v81
  v_cvt_pk_bf16_f32 v151, v82, v83
  s_nop 1
  v_permlane16_swap_b32 v148, v150
  v_permlane16_swap_b32 v149, v151
  buffer_store_dwordx4 v[148:151], v142, s[12:15], s71 offen sc1
  v_pk_fma_f32 v[84:85], v[232:233], v[114:115], v[84:85] op_sel_hi:[1,0,1]
  v_pk_fma_f32 v[86:87], v[234:235], v[114:115], v[86:87] op_sel_hi:[1,0,1]
  v_pk_mul_f32 v[84:85], v[84:85], v[122:123] op_sel_hi:[1,0]
  v_pk_mul_f32 v[86:87], v[86:87], v[122:123] op_sel_hi:[1,0]
  v_cvt_pk_bf16_f32 v144, v84, v85
  v_cvt_pk_bf16_f32 v145, v86, v87
  v_pk_fma_f32 v[88:89], v[236:237], v[114:115], v[88:89] op_sel_hi:[1,0,1]
  v_pk_fma_f32 v[90:91], v[238:239], v[114:115], v[90:91] op_sel_hi:[1,0,1]
  v_pk_mul_f32 v[88:89], v[88:89], v[122:123] op_sel_hi:[1,0]
  v_pk_mul_f32 v[90:91], v[90:91], v[122:123] op_sel_hi:[1,0]
  v_cvt_pk_bf16_f32 v146, v88, v89
  v_cvt_pk_bf16_f32 v147, v90, v91
  s_nop 1
  v_permlane16_swap_b32 v144, v146
  v_permlane16_swap_b32 v145, v147
  buffer_store_dwordx4 v[144:147], v143, s[12:15], s70 offen sc1
  v_pk_fma_f32 v[92:93], v[132:133], v[114:115], v[92:93] op_sel_hi:[1,0,1]
  v_pk_fma_f32 v[94:95], v[134:135], v[114:115], v[94:95] op_sel_hi:[1,0,1]
  v_pk_mul_f32 v[92:93], v[92:93], v[122:123] op_sel_hi:[1,0]
  v_pk_mul_f32 v[94:95], v[94:95], v[122:123] op_sel_hi:[1,0]
  v_cvt_pk_bf16_f32 v148, v92, v93
  v_cvt_pk_bf16_f32 v149, v94, v95
  v_pk_fma_f32 v[96:97], v[136:137], v[114:115], v[96:97] op_sel_hi:[1,0,1]
  v_pk_fma_f32 v[98:99], v[138:139], v[114:115], v[98:99] op_sel_hi:[1,0,1]
  v_pk_mul_f32 v[96:97], v[96:97], v[122:123] op_sel_hi:[1,0]
  v_pk_mul_f32 v[98:99], v[98:99], v[122:123] op_sel_hi:[1,0]
  v_cvt_pk_bf16_f32 v150, v96, v97
  v_cvt_pk_bf16_f32 v151, v98, v99
  s_nop 1
  v_permlane16_swap_b32 v148, v150
  v_permlane16_swap_b32 v149, v151
  buffer_store_dwordx4 v[148:151], v143, s[12:15], s71 offen sc1
  s_waitcnt vmcnt(0)
  s_barrier
  s_cmp_lg_u32 s20, 0
  s_cbranch_scc1 L_sig_11
  s_add_u32 s16, s60, 0x1a00000
  s_addc_u32 s17, s61, 0
  s_and_b32 s17, s17, 0xffff
  s_mov_b32 s18, 0x2000
  s_mov_b32 s19, 0x20000
  s_lshl_b32 s39, s21, 7
  s_lshl_b32 s40, s22, 3
  s_add_u32 s39, s39, s40
  v_mov_b32 v4, 0
  v_mov_b32 v12, s90
  v_mov_b32 v13, s91
  s_mov_b64 exec, 1
  buffer_store_dwordx2 v[12:13], v4, s[16:19], s39 offen sc1
  s_mov_b64 exec, -1
L_sig_11:
  s_branch L_p1_join_9
L_p1_ld_8:
  s_and_b32 s75, s23, 1
  s_mov_b32 s33, 0
  s_cmp_ge_u32 s23, 2
  s_cbranch_scc1 L_p1_ldA_12
  s_mov_b32 s4, s44
  s_and_b32 s5, s45, 0xffff
  s_mov_b32 s6, 0x280000
  s_mov_b32 s7, 0x20000
  s_lshl_b32 s62, s75, 10
  s_add_u32 s62, s62, 16384
  v_lshlrev_b32 v4, 1, v2
  v_xor_b32 v4, v4, v3
  v_lshlrev_b32 v4, 4, v4
  v_xor_b32 v6, 128, v4
  s_lshl_b32 s39, s75, 2
  v_add_u32 v5, s39, v2
  v_mul_u32_u24 v5, 3840, v5
  s_lshl_b32 s39, s29, 1
  v_add3_u32 v20, v4, v5, s39
  v_add3_u32 v21, v6, v5, s39
  v_add_u32 v21, 30720, v21
  v_add_u32 v22, 61440, v20
  v_add_u32 v23, 61440, v21
  v_add_u32 v24, 122880, v20
  v_add_u32 v25, 122880, v21
  v_add_u32 v26, 184320, v20
  v_add_u32 v27, 184320, v21
  s_mov_b32 s8, s46
  s_and_b32 s9, s47, 0xffff
  s_mov_b32 s10, 0x258000
  s_mov_b32 s11, 0x20000
  s_mov_b32 s31, 0
  s_add_u32 s39, s33, s62
  s_add_u32 m0, s39, 0
  s_nop 0
  buffer_load_dwordx4 v20, s[8:11], s31 offen lds
  s_add_u32 m0, s39, 2048
  s_nop 0
  buffer_load_dwordx4 v21, s[8:11], s31 offen lds
  s_add_u32 m0, s39, 4096
  s_nop 0
  buffer_load_dwordx4 v22, s[8:11], s31 offen lds
  s_add_u32 m0, s39, 6144
  s_nop 0
  buffer_load_dwordx4 v23, s[8:11], s31 offen lds
  s_add_u32 m0, s39, 8192
  s_nop 0
  buffer_load_dwordx4 v24, s[8:11], s31 offen lds
  s_add_u32 m0, s39, 10240
  s_nop 0
  buffer_load_dwordx4 v25, s[8:11], s31 offen lds
  s_add_u32 m0, s39, 12288
  s_nop 0
  buffer_load_dwordx4 v26, s[8:11], s31 offen lds
  s_add_u32 m0, s39, 14336
  s_nop 0
  buffer_load_dwordx4 v27, s[8:11], s31 offen lds
  s_add_u32 s31, s31, 245760
  s_add_u32 s36, s36, 1
  s_cmp_eq_u32 s36, 5
  s_cselect_b32 s35, s77, 32768
  s_cselect_b32 s36, 0, s36
  s_add_u32 s33, s33, s35
  s_add_u32 s39, s33, s62
  s_add_u32 m0, s39, 0
  s_nop 0
  buffer_load_dwordx4 v20, s[8:11], s31 offen lds
  s_add_u32 m0, s39, 2048
  s_nop 0
  buffer_load_dwordx4 v21, s[8:11], s31 offen lds
  s_add_u32 m0, s39, 4096
  s_nop 0
  buffer_load_dwordx4 v22, s[8:11], s31 offen lds
  s_add_u32 m0, s39, 6144
  s_nop 0
  buffer_load_dwordx4 v23, s[8:11], s31 offen lds
  s_add_u32 m0, s39, 8192
  s_nop 0
  buffer_load_dwordx4 v24, s[8:11], s31 offen lds
  s_add_u32 m0, s39, 10240
  s_nop 0
  buffer_load_dwordx4 v25, s[8:11], s31 offen lds
  s_add_u32 m0, s39, 12288
  s_nop 0
  buffer_load_dwordx4 v26, s[8:11], s31 offen lds
  s_add_u32 m0, s39, 14336
  s_nop 0
  buffer_load_dwordx4 v27, s[8:11], s31 offen lds
  s_add_u32 s31, s31, 245760
  s_add_u32 s36, s36, 1
  s_cmp_eq_u32 s36, 5
  s_cselect_b32 s35, s77, 32768
  s_cselect_b32 s36, 0, s36
  s_add_u32 s33, s33, s35
  s_waitcnt vmcnt(8)
  s_barrier
  s_add_u32 s39, s33, s62
  s_add_u32 m0, s39, 0
  s_nop 0
  buffer_load_dwordx4 v20, s[8:11], s31 offen lds
  s_add_u32 m0, s39, 2048
  s_nop 0
  buffer_load_dwordx4 v21, s[8:11], s31 offen lds
  s_add_u32 m0, s39, 4096
  s_nop 0
  buffer_load_dwordx4 v22, s[8:11], s31 offen lds
  s_add_u32 m0, s39, 6144
  s_nop 0
  buffer_load_dwordx4 v23, s[8:11], s31 offen lds
  s_add_u32 m0, s39, 8192
  s_nop 0
  buffer_load_dwordx4 v24, s[8:11], s31 offen lds
  s_add_u32 m0, s39, 10240
  s_nop 0
  buffer_load_dwordx4 v25, s[8:11], s31 offen lds
  s_add_u32 m0, s39, 12288
  s_nop 0
  buffer_load_dwordx4 v26, s[8:11], s31 offen lds
  s_add_u32 m0, s39, 14336
  s_nop 0
  buffer_load_dwordx4 v27, s[8:11], s31 offen lds
  s_add_u32 s31, s31, 245760
  s_add_u32 s36, s36, 1
  s_cmp_eq_u32 s36, 5
  s_cselect_b32 s35, s77, 32768
  s_cselect_b32 s36, 0, s36
  s_add_u32 s33, s33, s35
  s_add_u32 s39, s33, s62
  s_add_u32 m0, s39, 0
  s_nop 0
  buffer_load_dwordx4 v20, s[8:11], s31 offen lds
  s_add_u32 m0, s39, 2048
  s_nop 0
  buffer_load_dwordx4 v21, s[8:11], s31 offen lds
  s_add_u32 m0, s39, 4096
  s_nop 0
  buffer_load_dwordx4 v22, s[8:11], s31 offen lds
  s_add_u32 m0, s39, 6144
  s_nop 0
  buffer_load_dwordx4 v23, s[8:11], s31 offen lds
  s_add_u32 m0, s39, 8192
  s_nop 0
  buffer_load_dwordx4 v24, s[8:11], s31 offen lds
  s_add_u32 m0, s39, 10240
  s_nop 0
  buffer_load_dwordx4 v25, s[8:11], s31 offen lds
  s_add_u32 m0, s39, 12288
  s_nop 0
  buffer_load_dwordx4 v26, s[8:11], s31 offen lds
  s_add_u32 m0, s39, 14336
  s_nop 0
  buffer_load_dwordx4 v27, s[8:11], s31 offen lds
  s_add_u32 s31, s31, 245760
  s_add_u32 s36, s36, 1
  s_cmp_eq_u32 s36, 5
  s_cselect_b32 s35, s77, 32768
  s_cselect_b32 s36, 0, s36
  s_add_u32 s33, s33, s35
  s_mov_b32 s30, 0
L_p1_ll_14:
  s_waitcnt vmcnt(16)
  s_barrier
  s_add_u32 s39, s33, s62
  s_add_u32 m0, s39, 0
  s_nop 0
  buffer_load_dwordx4 v20, s[8:11], s31 offen lds
  s_add_u32 m0, s39, 2048
  s_nop 0
  buffer_load_dwordx4 v21, s[8:11], s31 offen lds
  s_add_u32 m0, s39, 4096
  s_nop 0
  buffer_load_dwordx4 v22, s[8:11], s31 offen lds
  s_add_u32 m0, s39, 6144
  s_nop 0
  buffer_load_dwordx4 v23, s[8:11], s31 offen lds
  s_add_u32 m0, s39, 8192
  s_nop 0
  buffer_load_dwordx4 v24, s[8:11], s31 offen lds
  s_add_u32 m0, s39, 10240
  s_nop 0
  buffer_load_dwordx4 v25, s[8:11], s31 offen lds
  s_add_u32 m0, s39, 12288
  s_nop 0
  buffer_load_dwordx4 v26, s[8:11], s31 offen lds
  s_add_u32 m0, s39, 14336
  s_nop 0
  buffer_load_dwordx4 v27, s[8:11], s31 offen lds
  s_add_u32 s31, s31, 245760
  s_add_u32 s36, s36, 1
  s_cmp_eq_u32 s36, 5
  s_cselect_b32 s35, s77, 32768
  s_cselect_b32 s36, 0, s36
  s_add_u32 s33, s33, s35
  s_add_u32 s30, s30, 1
  s_cmp_lt_u32 s30, 5
  s_cbranch_scc1 L_p1_ll_14
  s_waitcnt vmcnt(16)
  s_barrier
  s_add_u32 s39, s33, s62
  s_add_u32 m0, s39, 0
  s_nop 0
  buffer_load_dwordx4 v20, s[8:11], s31 offen lds
  s_add_u32 m0, s39, 2048
  s_nop 0
  buffer_load_dwordx4 v21, s[8:11], s31 offen lds
  s_add_u32 m0, s39, 4096
  s_nop 0
  buffer_load_dwordx4 v22, s[8:11], s31 offen lds
  s_add_u32 m0, s39, 6144
  s_nop 0
  buffer_load_dwordx4 v23, s[8:11], s31 offen lds
  s_add_u32 m0, s39, 8192
  s_nop 0
  buffer_load_dwordx4 v24, s[8:11], s31 offen lds
  s_add_u32 m0, s39, 10240
  s_nop 0
  buffer_load_dwordx4 v25, s[8:11], s31 offen lds
  s_add_u32 m0, s39, 12288
  s_nop 0
  buffer_load_dwordx4 v26, s[8:11], s31 offen lds
  s_add_u32 m0, s39, 14336
  s_nop 0
  buffer_load_dwordx4 v27, s[8:11], s31 offen lds
  s_add_u32 s31, s31, 245760
  s_add_u32 s36, s36, 1
  s_cmp_eq_u32 s36, 5
  s_cselect_b32 s35, s77, 32768
  s_cselect_b32 s36, 0, s36
  s_add_u32 s33, s33, s35
  v_mov_b32 v4, 0
  buffer_load_dwordx2 v[8:9], v4, s[24:27], 0 offen sc1
  s_add_u32 s16, s60, 0x1a40000
  s_addc_u32 s17, s61, 0
  s_and_b32 s17, s17, 0xffff
  s_mov_b32 s18, 0x8000
  s_mov_b32 s19, 0x20000
  s_lshl_b32 s39, s23, 5
  v_add_u32 v41, s39, v1
  v_add_u32 v40, s28, v41
  v_lshlrev_b32 v40, 4, v40
  s_mov_b32 exec_hi, 0
  buffer_load_dwordx4 v[36:39], v40, s[16:19], 0 offen sc1
  s_mov_b32 exec_hi, -1
  s_waitcnt vmcnt(18)
  s_barrier
  s_waitcnt vmcnt(10)
  s_barrier
  s_waitcnt vmcnt(2)
  s_barrier
  s_branch L_p1_ldT_13
L_p1_ldA_12:
  s_lshl_b32 s62, s75, 10
  s_lshl_b32 s39, s75, 2
  v_add_u32 v4, s39, v2
  v_and_b32 v4, 7, v4
  v_and_b32 v5, 7, v1
  v_xor_b32 v4, v4, v5
  v_lshlrev_b32 v4, 4, v4
  v_lshrrev_b32 v5, 3, v1
  s_lshl_b32 s39, s75, 3
  s_add_u32 s39, s39, s28
  v_add_u32 v5, s39, v5
  v_mul_u32_u24 v5, 1280, v5
  v_add_u32 v20, v4, v5
  v_add_u32 v21, 20480, v20
  v_add_u32 v22, 40960, v20
  v_add_u32 v23, 61440, v20
  v_add_u32 v24, 81920, v20
  v_add_u32 v25, 102400, v20
  v_add_u32 v26, 122880, v20
  v_add_u32 v27, 143360, v20
  s_mov_b32 s4, s44
  s_and_b32 s5, s45, 0xffff
  s_mov_b32 s6, 0x280000
  s_mov_b32 s7, 0x20000
  s_mov_b32 s31, 0
  s_add_u32 s39, s33, s62
  s_add_u32 m0, s39, 0
  s_nop 0
  buffer_load_dwordx4 v20, s[4:7], s31 offen lds
  s_add_u32 m0, s39, 2048
  s_nop 0
  buffer_load_dwordx4 v21, s[4:7], s31 offen lds
  s_add_u32 m0, s39, 4096
  s_nop 0
  buffer_load_dwordx4 v22, s[4:7], s31 offen lds
  s_add_u32 m0, s39, 6144
  s_nop 0
  buffer_load_dwordx4 v23, s[4:7], s31 offen lds
  s_add_u32 m0, s39, 8192
  s_nop 0
  buffer_load_dwordx4 v24, s[4:7], s31 offen lds
  s_add_u32 m0, s39, 10240
  s_nop 0
  buffer_load_dwordx4 v25, s[4:7], s31 offen lds
  s_add_u32 m0, s39, 12288
  s_nop 0
  buffer_load_dwordx4 v26, s[4:7], s31 offen lds
  s_add_u32 m0, s39, 14336
  s_nop 0
  buffer_load_dwordx4 v27, s[4:7], s31 offen lds
  s_add_u32 s31, s31, 128
  s_add_u32 s36, s36, 1
  s_cmp_eq_u32 s36, 5
  s_cselect_b32 s35, s77, 32768
  s_cselect_b32 s36, 0, s36
  s_add_u32 s33, s33, s35
  s_add_u32 s39, s33, s62
  s_add_u32 m0, s39, 0
  s_nop 0
  buffer_load_dwordx4 v20, s[4:7], s31 offen lds
  s_add_u32 m0, s39, 2048
  s_nop 0
  buffer_load_dwordx4 v21, s[4:7], s31 offen lds
  s_add_u32 m0, s39, 4096
  s_nop 0
  buffer_load_dwordx4 v22, s[4:7], s31 offen lds
  s_add_u32 m0, s39, 6144
  s_nop 0
  buffer_load_dwordx4 v23, s[4:7], s31 offen lds
  s_add_u32 m0, s39, 8192
  s_nop 0
  buffer_load_dwordx4 v24, s[4:7], s31 offen lds
  s_add_u32 m0, s39, 10240
  s_nop 0
  buffer_load_dwordx4 v25, s[4:7], s31 offen lds
  s_add_u32 m0, s39, 12288
  s_nop 0
  buffer_load_dwordx4 v26, s[4:7], s31 offen lds
  s_add_u32 m0, s39, 14336
  s_nop 0
  buffer_load_dwordx4 v27, s[4:7], s31 offen lds
  s_add_u32 s31, s31, 128
  s_add_u32 s36, s36, 1
  s_cmp_eq_u32 s36, 5
  s_cselect_b32 s35, s77, 32768
  s_cselect_b32 s36, 0, s36
  s_add_u32 s33, s33, s35
  s_waitcnt vmcnt(8)
  s_barrier
  s_add_u32 s39, s33, s62
  s_add_u32 m0, s39, 0
  s_nop 0
  buffer_load_dwordx4 v20, s[4:7], s31 offen lds
  s_add_u32 m0, s39, 2048
  s_nop 0
  buffer_load_dwordx4 v21, s[4:7], s31 offen lds
  s_add_u32 m0, s39, 4096
  s_nop 0
  buffer_load_dwordx4 v22, s[4:7], s31 offen lds
  s_add_u32 m0, s39, 6144
  s_nop 0
  buffer_load_dwordx4 v23, s[4:7], s31 offen lds
  s_add_u32 m0, s39, 8192
  s_nop 0
  buffer_load_dwordx4 v24, s[4:7], s31 offen lds
  s_add_u32 m0, s39, 10240
  s_nop 0
  buffer_load_dwordx4 v25, s[4:7], s31 offen lds
  s_add_u32 m0, s39, 12288
  s_nop 0
  buffer_load_dwordx4 v26, s[4:7], s31 offen lds
  s_add_u32 m0, s39, 14336
  s_nop 0
  buffer_load_dwordx4 v27, s[4:7], s31 offen lds
  s_add_u32 s31, s31, 128
  s_add_u32 s36, s36, 1
  s_cmp_eq_u32 s36, 5
  s_cselect_b32 s35, s77, 32768
  s_cselect_b32 s36, 0, s36
  s_add_u32 s33, s33, s35
  s_add_u32 s39, s33, s62
  s_add_u32 m0, s39, 0
  s_nop 0
  buffer_load_dwordx4 v20, s[4:7], s31 offen lds
  s_add_u32 m0, s39, 2048
  s_nop 0
  buffer_load_dwordx4 v21, s[4:7], s31 offen lds
  s_add_u32 m0, s39, 4096
  s_nop 0
  buffer_load_dwordx4 v22, s[4:7], s31 offen lds
  s_add_u32 m0, s39, 6144
  s_nop 0
  buffer_load_dwordx4 v23, s[4:7], s31 offen lds
  s_add_u32 m0, s39, 8192
  s_nop 0
  buffer_load_dwordx4 v24, s[4:7], s31 offen lds
  s_add_u32 m0, s39, 10240
  s_nop 0
  buffer_load_dwordx4 v25, s[4:7], s31 offen lds
  s_add_u32 m0, s39, 12288
  s_nop 0
  buffer_load_dwordx4 v26, s[4:7], s31 offen lds
  s_add_u32 m0, s39, 14336
  s_nop 0
  buffer_load_dwordx4 v27, s[4:7], s31 offen lds
  s_add_u32 s31, s31, 128
  s_add_u32 s36, s36, 1
  s_cmp_eq_u32 s36, 5
  s_cselect_b32 s35, s77, 32768
  s_cselect_b32 s36, 0, s36
  s_add_u32 s33, s33, s35
  s_mov_b32 s30, 0
L_p1_ll_15:
  s_waitcnt vmcnt(16)
  s_barrier
  s_add_u32 s39, s33, s62
  s_add_u32 m0, s39, 0
  s_nop 0
  buffer_load_dwordx4 v20, s[4:7], s31 offen lds
  s_add_u32 m0, s39, 2048
  s_nop 0
  buffer_load_dwordx4 v21, s[4:7], s31 offen lds
  s_add_u32 m0, s39, 4096
  s_nop 0
  buffer_load_dwordx4 v22, s[4:7], s31 offen lds
  s_add_u32 m0, s39, 6144
  s_nop 0
  buffer_load_dwordx4 v23, s[4:7], s31 offen lds
  s_add_u32 m0, s39, 8192
  s_nop 0
  buffer_load_dwordx4 v24, s[4:7], s31 offen lds
  s_add_u32 m0, s39, 10240
  s_nop 0
  buffer_load_dwordx4 v25, s[4:7], s31 offen lds
  s_add_u32 m0, s39, 12288
  s_nop 0
  buffer_load_dwordx4 v26, s[4:7], s31 offen lds
  s_add_u32 m0, s39, 14336
  s_nop 0
  buffer_load_dwordx4 v27, s[4:7], s31 offen lds
  s_add_u32 s31, s31, 128
  s_add_u32 s36, s36, 1
  s_cmp_eq_u32 s36, 5
  s_cselect_b32 s35, s77, 32768
  s_cselect_b32 s36, 0, s36
  s_add_u32 s33, s33, s35
  s_add_u32 s30, s30, 1
  s_cmp_lt_u32 s30, 5
  s_cbranch_scc1 L_p1_ll_15
  s_waitcnt vmcnt(16)
  s_barrier
  s_add_u32 s39, s33, s62
  s_add_u32 m0, s39, 0
  s_nop 0
  buffer_load_dwordx4 v20, s[4:7], s31 offen lds
  s_add_u32 m0, s39, 2048
  s_nop 0
  buffer_load_dwordx4 v21, s[4:7], s31 offen lds
  s_add_u32 m0, s39, 4096
  s_nop 0
  buffer_load_dwordx4 v22, s[4:7], s31 offen lds
  s_add_u32 m0, s39, 6144
  s_nop 0
  buffer_load_dwordx4 v23, s[4:7], s31 offen lds
  s_add_u32 m0, s39, 8192
  s_nop 0
  buffer_load_dwordx4 v24, s[4:7], s31 offen lds
  s_add_u32 m0, s39, 10240
  s_nop 0
  buffer_load_dwordx4 v25, s[4:7], s31 offen lds
  s_add_u32 m0, s39, 12288
  s_nop 0
  buffer_load_dwordx4 v26, s[4:7], s31 offen lds
  s_add_u32 m0, s39, 14336
  s_nop 0
  buffer_load_dwordx4 v27, s[4:7], s31 offen lds
  s_add_u32 s31, s31, 128
  s_add_u32 s36, s36, 1
  s_cmp_eq_u32 s36, 5
  s_cselect_b32 s35, s77, 32768
  s_cselect_b32 s36, 0, s36
  s_add_u32 s33, s33, s35
  v_mov_b32 v4, 0
  buffer_load_dwordx2 v[8:9], v4, s[24:27], 0 offen sc1
  s_add_u32 s16, s60, 0x1a40000
  s_addc_u32 s17, s61, 0
  s_and_b32 s17, s17, 0xffff
  s_mov_b32 s18, 0x8000
  s_mov_b32 s19, 0x20000
  s_lshl_b32 s39, s23, 5
  v_add_u32 v41, s39, v1
  v_add_u32 v40, s28, v41
  v_lshlrev_b32 v40, 4, v40
  s_mov_b32 exec_hi, 0
  buffer_load_dwordx4 v[36:39], v40, s[16:19], 0 offen sc1
  s_mov_b32 exec_hi, -1
  s_waitcnt vmcnt(18)
  s_barrier
  s_waitcnt vmcnt(10)
  s_barrier
  s_waitcnt vmcnt(2)
  s_barrier
L_p1_ldT_13:
  s_waitcnt vmcnt(0)
  s_mov_b32 s86, 0
L_tag_16:
  v_readfirstlane_b32 s90, v8
  v_readfirstlane_b32 s91, v9
  s_add_u32 s86, s86, 1
  s_cmp_lg_u32 s90, 0
  s_cbranch_scc1 L_tagd_17
  s_cmp_ge_u32 s86, 0x40000
  s_cbranch_scc1 L_tagd_17
  s_sleep 2
  v_mov_b32 v4, 0
  buffer_load_dwordx2 v[8:9], v4, s[24:27], 0 offen sc1
  s_waitcnt vmcnt(0)
  s_branch L_tag_16
L_tagd_17:
  s_mov_b32 exec_hi, 0
  s_mov_b32 s86, 0
L_rsp_18:
  v_xor_b32 v38, s90, v38
  v_xor_b32 v39, s91, v39
  v_or_b32 v38, v38, v39
  v_cmp_eq_u32 vcc, 0, v38
  s_add_u32 s86, s86, 1
  s_cmp_eq_u64 vcc, exec
  s_cbranch_scc1 L_rsd_19
  s_cmp_ge_u32 s86, 0x40000
  s_cbranch_scc1 L_rsd_19
  s_sleep 2
  buffer_load_dwordx4 v[36:39], v40, s[16:19], 0 offen sc1
  s_waitcnt vmcnt(0)
  s_branch L_rsp_18
L_rsd_19:
  v_lshlrev_b32 v5, 3, v41
  v_add_u32 v5, 65536, v5
  ds_write_b64 v5, v[36:37]
  s_mov_b32 exec_hi, -1
  s_waitcnt lgkmcnt(0)
  s_barrier
  s_barrier
L_p1_join_9:
  s_branch L_p2_7
L_p1b_6:
  s_add_u32 s12, s60, 0x1600000
  s_addc_u32 s13, s61, 0
  s_and_b32 s13, s13, 0xffff
  s_mov_b32 s14, 0x2e4000
  s_mov_b32 s15, 0x20000
  s_mov_b32 s7, 0x20000
  s_mov_b32 s88, 819200
  s_lshl_b32 s30, s21, 3
  s_add_u32 s30, s30, s20
  s_mul_i32 s34, s30, 17408
  s_mov_b32 s89, s30
  s_mov_b32 s87, 0x1999999a
  v_lshlrev_b32 v21, 4, v1
  s_cmp_ge_u32 s30, 800
  s_cselect_b32 s4, s54, s48
  s_cselect_b32 s5, s55, s49
  s_cselect_b32 s6, 2211840, s88
  s_cselect_b32 s43, 800, 0
  s_cselect_b32 s31, 27, 10
  s_cselect_b32 s32, 0x97b425f, s87
  s_and_b32 s5, s5, 0xffff
  s_sub_u32 s43, s30, s43
  s_mul_hi_u32 s39, s43, s87
  s_mul_i32 s40, s39, 10
  s_sub_u32 s40, s43, s40
  s_mul_hi_u32 s41, s39, s32
  s_mul_i32 s42, s41, s31
  s_sub_u32 s42, s39, s42
  s_lshl_b32 s40, s40, 6
  v_add_u32 v4, s40, v1
  v_mul_hi_u32 v5, v4, s87
  v_mul_u32_u24 v6, 10, v5
  v_sub_u32 v4, v4, v6
  v_lshlrev_b32 v4, 4, v4
  v_and_b32 v20, 0x23, v5
  v_bfe_u32 v6, v5, 2, 2
  v_lshl_add_u32 v20, v6, 3, v20
  v_bfe_u32 v6, v5, 4, 1
  v_lshl_add_u32 v20, v6, 2, v20
  v_mul_u32_u24 v20, 1280, v20
  v_add_u32 v20, v20, v4
  s_mul_i32 s42, s42, 81920
  s_mul_i32 s41, s41, 160
  s_add_u32 s42, s42, s41
  buffer_load_dwordx4 v[24:27], v20, s[4:7], s42 offen
  s_add_u32 s30, s30, 128
  s_cmp_ge_u32 s30, 800
  s_cselect_b32 s4, s54, s48
  s_cselect_b32 s5, s55, s49
  s_cselect_b32 s6, 2211840, s88
  s_cselect_b32 s43, 800, 0
  s_cselect_b32 s31, 27, 10
  s_cselect_b32 s32, 0x97b425f, s87
  s_and_b32 s5, s5, 0xffff
  s_sub_u32 s43, s30, s43
  s_mul_hi_u32 s39, s43, s87
  s_mul_i32 s40, s39, 10
  s_sub_u32 s40, s43, s40
  s_mul_hi_u32 s41, s39, s32
  s_mul_i32 s42, s41, s31
  s_sub_u32 s42, s39, s42
  s_lshl_b32 s40, s40, 6
  v_add_u32 v4, s40, v1
  v_mul_hi_u32 v5, v4, s87
  v_mul_u32_u24 v6, 10, v5
  v_sub_u32 v4, v4, v6
  v_lshlrev_b32 v4, 4, v4
  v_and_b32 v20, 0x23, v5
  v_bfe_u32 v6, v5, 2, 2
  v_lshl_add_u32 v20, v6, 3, v20
  v_bfe_u32 v6, v5, 4, 1
  v_lshl_add_u32 v20, v6, 2, v20
  v_mul_u32_u24 v20, 1280, v20
  v_add_u32 v20, v20, v4
  s_mul_i32 s42, s42, 81920
  s_mul_i32 s41, s41, 160
  s_add_u32 s42, s42, s41
  buffer_load_dwordx4 v[28:31], v20, s[4:7], s42 offen
  s_add_u32 s30, s30, 128
  s_cmp_ge_u32 s30, 800
  s_cselect_b32 s4, s54, s48
  s_cselect_b32 s5, s55, s49
  s_cselect_b32 s6, 2211840, s88
  s_cselect_b32 s43, 800, 0
  s_cselect_b32 s31, 27, 10
  s_cselect_b32 s32, 0x97b425f, s87
  s_and_b32 s5, s5, 0xffff
  s_sub_u32 s43, s30, s43
  s_mul_hi_u32 s39, s43, s87
  s_mul_i32 s40, s39, 10
  s_sub_u32 s40, s43, s40
  s_mul_hi_u32 s41, s39, s32
  s_mul_i32 s42, s41, s31
  s_sub_u32 s42, s39, s42
  s_lshl_b32 s40, s40, 6
  v_add_u32 v4, s40, v1
  v_mul_hi_u32 v5, v4, s87
  v_mul_u32_u24 v6, 10, v5
  v_sub_u32 v4, v4, v6
  v_lshlrev_b32 v4, 4, v4
  v_and_b32 v20, 0x23, v5
  v_bfe_u32 v6, v5, 2, 2
  v_lshl_add_u32 v20, v6, 3, v20
  v_bfe_u32 v6, v5, 4, 1
  v_lshl_add_u32 v20, v6, 2, v20
  v_mul_u32_u24 v20, 1280, v20
  v_add_u32 v20, v20, v4
  s_mul_i32 s42, s42, 81920
  s_mul_i32 s41, s41, 160
  s_add_u32 s42, s42, s41
  buffer_load_dwordx4 v[32:35], v20, s[4:7], s42 offen
  s_add_u32 s30, s30, 128
  s_cmp_ge_u32 s30, 800
  s_cselect_b32 s4, s54, s48
  s_cselect_b32 s5, s55, s49
  s_cselect_b32 s6, 2211840, s88
  s_cselect_b32 s43, 800, 0
  s_cselect_b32 s31, 27, 10
  s_cselect_b32 s32, 0x97b425f, s87
  s_and_b32 s5, s5, 0xffff
  s_sub_u32 s43, s30, s43
  s_mul_hi_u32 s39, s43, s87
  s_mul_i32 s40, s39, 10
  s_sub_u32 s40, s43, s40
  s_mul_hi_u32 s41, s39, s32
  s_mul_i32 s42, s41, s31
  s_sub_u32 s42, s39, s42
  s_lshl_b32 s40, s40, 6
  v_add_u32 v4, s40, v1
  v_mul_hi_u32 v5, v4, s87
  v_mul_u32_u24 v6, 10, v5
  v_sub_u32 v4, v4, v6
  v_lshlrev_b32 v4, 4, v4
  v_and_b32 v20, 0x23, v5
  v_bfe_u32 v6, v5, 2, 2
  v_lshl_add_u32 v20, v6, 3, v20
  v_bfe_u32 v6, v5, 4, 1
  v_lshl_add_u32 v20, v6, 2, v20
  v_mul_u32_u24 v20, 1280, v20
  v_add_u32 v20, v20, v4
  s_mul_i32 s42, s42, 81920
  s_mul_i32 s41, s41, 160
  s_add_u32 s42, s42, s41
  buffer_load_dwordx4 v[36:39], v20, s[4:7], s42 offen
  s_add_u32 s30, s30, 128
  s_cmp_ge_u32 s30, 800
  s_cselect_b32 s4, s54, s48
  s_cselect_b32 s5, s55, s49
  s_cselect_b32 s6, 2211840, s88
  s_cselect_b32 s43, 800, 0
  s_cselect_b32 s31, 27, 10
  s_cselect_b32 s32, 0x97b425f, s87
  s_and_b32 s5, s5, 0xffff
  s_sub_u32 s43, s30, s43
  s_mul_hi_u32 s39, s43, s87
  s_mul_i32 s40, s39, 10
  s_sub_u32 s40, s43, s40
  s_mul_hi_u32 s41, s39, s32
  s_mul_i32 s42, s41, s31
  s_sub_u32 s42, s39, s42
  s_lshl_b32 s40, s40, 6
  v_add_u32 v4, s40, v1
  v_mul_hi_u32 v5, v4, s87
  v_mul_u32_u24 v6, 10, v5
  v_sub_u32 v4, v4, v6
  v_lshlrev_b32 v4, 4, v4
  v_and_b32 v20, 0x23, v5
  v_bfe_u32 v6, v5, 2, 2
  v_lshl_add_u32 v20, v6, 3, v20
  v_bfe_u32 v6, v5, 4, 1
  v_lshl_add_u32 v20, v6, 2, v20
  v_mul_u32_u24 v20, 1280, v20
  v_add_u32 v20, v20, v4
  s_mul_i32 s42, s42, 81920
  s_mul_i32 s41, s41, 160
  s_add_u32 s42, s42, s41
  buffer_load_dwordx4 v[40:43], v20, s[4:7], s42 offen
  s_add_u32 s30, s30, 128
  s_cmp_ge_u32 s30, 800
  s_cselect_b32 s4, s54, s48
  s_cselect_b32 s5, s55, s49
  s_cselect_b32 s6, 2211840, s88
  s_cselect_b32 s43, 800, 0
  s_cselect_b32 s31, 27, 10
  s_cselect_b32 s32, 0x97b425f, s87
  s_and_b32 s5, s5, 0xffff
  s_sub_u32 s43, s30, s43
  s_mul_hi_u32 s39, s43, s87
  s_mul_i32 s40, s39, 10
  s_sub_u32 s40, s43, s40
  s_mul_hi_u32 s41, s39, s32
  s_mul_i32 s42, s41, s31
  s_sub_u32 s42, s39, s42
  s_lshl_b32 s40, s40, 6
  v_add_u32 v4, s40, v1
  v_mul_hi_u32 v5, v4, s87
  v_mul_u32_u24 v6, 10, v5
  v_sub_u32 v4, v4, v6
  v_lshlrev_b32 v4, 4, v4
  v_and_b32 v20, 0x23, v5
  v_bfe_u32 v6, v5, 2, 2
  v_lshl_add_u32 v20, v6, 3, v20
  v_bfe_u32 v6, v5, 4, 1
  v_lshl_add_u32 v20, v6, 2, v20
  v_mul_u32_u24 v20, 1280, v20
  v_add_u32 v20, v20, v4
  s_mul_i32 s42, s42, 81920
  s_mul_i32 s41, s41, 160
  s_add_u32 s42, s42, s41
  buffer_load_dwordx4 v[44:47], v20, s[4:7], s42 offen
  s_add_u32 s30, s30, 128
  s_cmp_ge_u32 s30, 800
  s_cselect_b32 s4, s54, s48
  s_cselect_b32 s5, s55, s49
  s_cselect_b32 s6, 2211840, s88
  s_cselect_b32 s43, 800, 0
  s_cselect_b32 s31, 27, 10
  s_cselect_b32 s32, 0x97b425f, s87
  s_and_b32 s5, s5, 0xffff
  s_sub_u32 s43, s30, s43
  s_mul_hi_u32 s39, s43, s87
  s_mul_i32 s40, s39, 10
  s_sub_u32 s40, s43, s40
  s_mul_hi_u32 s41, s39, s32
  s_mul_i32 s42, s41, s31
  s_sub_u32 s42, s39, s42
  s_lshl_b32 s40, s40, 6
  v_add_u32 v4, s40, v1
  v_mul_hi_u32 v5, v4, s87
  v_mul_u32_u24 v6, 10, v5
  v_sub_u32 v4, v4, v6
  v_lshlrev_b32 v4, 4, v4
  v_and_b32 v20, 0x23, v5
  v_bfe_u32 v6, v5, 2, 2
  v_lshl_add_u32 v20, v6, 3, v20
  v_bfe_u32 v6, v5, 4, 1
  v_lshl_add_u32 v20, v6, 2, v20
  v_mul_u32_u24 v20, 1280, v20
  v_add_u32 v20, v20, v4
  s_mul_i32 s42, s42, 81920
  s_mul_i32 s41, s41, 160
  s_add_u32 s42, s42, s41
  buffer_load_dwordx4 v[48:51], v20, s[4:7], s42 offen
  s_add_u32 s30, s30, 128
  s_cmp_ge_u32 s30, 800
  s_cselect_b32 s4, s54, s48
  s_cselect_b32 s5, s55, s49
  s_cselect_b32 s6, 2211840, s88
  s_cselect_b32 s43, 800, 0
  s_cselect_b32 s31, 27, 10
  s_cselect_b32 s32, 0x97b425f, s87
  s_and_b32 s5, s5, 0xffff
  s_sub_u32 s43, s30, s43
  s_mul_hi_u32 s39, s43, s87
  s_mul_i32 s40, s39, 10
  s_sub_u32 s40, s43, s40
  s_mul_hi_u32 s41, s39, s32
  s_mul_i32 s42, s41, s31
  s_sub_u32 s42, s39, s42
  s_lshl_b32 s40, s40, 6
  v_add_u32 v4, s40, v1
  v_mul_hi_u32 v5, v4, s87
  v_mul_u32_u24 v6, 10, v5
  v_sub_u32 v4, v4, v6
  v_lshlrev_b32 v4, 4, v4
  v_and_b32 v20, 0x23, v5
  v_bfe_u32 v6, v5, 2, 2
  v_lshl_add_u32 v20, v6, 3, v20
  v_bfe_u32 v6, v5, 4, 1
  v_lshl_add_u32 v20, v6, 2, v20
  v_mul_u32_u24 v20, 1280, v20
  v_add_u32 v20, v20, v4
  s_mul_i32 s42, s42, 81920
  s_mul_i32 s41, s41, 160
  s_add_u32 s42, s42, s41
  buffer_load_dwordx4 v[52:55], v20, s[4:7], s42 offen
  s_add_u32 s30, s30, 128
  s_cmp_ge_u32 s30, 800
  s_cselect_b32 s4, s54, s48
  s_cselect_b32 s5, s55, s49
  s_cselect_b32 s6, 2211840, s88
  s_cselect_b32 s43, 800, 0
  s_cselect_b32 s31, 27, 10
  s_cselect_b32 s32, 0x97b425f, s87
  s_and_b32 s5, s5, 0xffff
  s_sub_u32 s43, s30, s43
  s_mul_hi_u32 s39, s43, s87
  s_mul_i32 s40, s39, 10
  s_sub_u32 s40, s43, s40
  s_mul_hi_u32 s41, s39, s32
  s_mul_i32 s42, s41, s31
  s_sub_u32 s42, s39, s42
  s_lshl_b32 s40, s40, 6
  v_add_u32 v4, s40, v1
  v_mul_hi_u32 v5, v4, s87
  v_mul_u32_u24 v6, 10, v5
  v_sub_u32 v4, v4, v6
  v_lshlrev_b32 v4, 4, v4
  v_and_b32 v20, 0x23, v5
  v_bfe_u32 v6, v5, 2, 2
  v_lshl_add_u32 v20, v6, 3, v20
  v_bfe_u32 v6, v5, 4, 1
  v_lshl_add_u32 v20, v6, 2, v20
  v_mul_u32_u24 v20, 1280, v20
  v_add_u32 v20, v20, v4
  s_mul_i32 s42, s42, 81920
  s_mul_i32 s41, s41, 160
  s_add_u32 s42, s42, s41
  buffer_load_dwordx4 v[56:59], v20, s[4:7], s42 offen
  s_add_u32 s30, s30, 128
  s_cmp_ge_u32 s30, 800
  s_cselect_b32 s4, s54, s48
  s_cselect_b32 s5, s55, s49
  s_cselect_b32 s6, 2211840, s88
  s_cselect_b32 s43, 800, 0
  s_cselect_b32 s31, 27, 10
  s_cselect_b32 s32, 0x97b425f, s87
  s_and_b32 s5, s5, 0xffff
  s_sub_u32 s43, s30, s43
  s_mul_hi_u32 s39, s43, s87
  s_mul_i32 s40, s39, 10
  s_sub_u32 s40, s43, s40
  s_mul_hi_u32 s41, s39, s32
  s_mul_i32 s42, s41, s31
  s_sub_u32 s42, s39, s42
  s_lshl_b32 s40, s40, 6
  v_add_u32 v4, s40, v1
  v_mul_hi_u32 v5, v4, s87
  v_mul_u32_u24 v6, 10, v5
  v_sub_u32 v4, v4, v6
  v_lshlrev_b32 v4, 4, v4
  v_and_b32 v20, 0x23, v5
  v_bfe_u32 v6, v5, 2, 2
  v_lshl_add_u32 v20, v6, 3, v20
  v_bfe_u32 v6, v5, 4, 1
  v_lshl_add_u32 v20, v6, 2, v20
  v_mul_u32_u24 v20, 1280, v20
  v_add_u32 v20, v20, v4
  s_mul_i32 s42, s42, 81920
  s_mul_i32 s41, s41, 160
  s_add_u32 s42, s42, s41
  buffer_load_dwordx4 v[60:63], v20, s[4:7], s42 offen
  s_add_u32 s30, s30, 128
  s_lshl_b32 s39, s89, 10
  s_add_u32 s89, s89, 128
  s_waitcnt vmcnt(9)
  buffer_store_dwordx4 v[24:27], v21, s[12:15], s39 offen sc1
  s_lshl_b32 s39, s89, 10
  s_add_u32 s89, s89, 128
  s_waitcnt vmcnt(9)
  buffer_store_dwordx4 v[28:31], v21, s[12:15], s39 offen sc1
  s_lshl_b32 s39, s89, 10
  s_add_u32 s89, s89, 128
  s_waitcnt vmcnt(9)
  buffer_store_dwordx4 v[32:35], v21, s[12:15], s39 offen sc1
  s_lshl_b32 s39, s89, 10
  s_add_u32 s89, s89, 128
  s_waitcnt vmcnt(9)
  buffer_store_dwordx4 v[36:39], v21, s[12:15], s39 offen sc1
  s_lshl_b32 s39, s89, 10
  s_add_u32 s89, s89, 128
  s_waitcnt vmcnt(9)
  buffer_store_dwordx4 v[40:43], v21, s[12:15], s39 offen sc1
  s_lshl_b32 s39, s89, 10
  s_add_u32 s89, s89, 128
  s_waitcnt vmcnt(9)
  buffer_store_dwordx4 v[44:47], v21, s[12:15], s39 offen sc1
  s_lshl_b32 s39, s89, 10
  s_add_u32 s89, s89, 128
  s_waitcnt vmcnt(9)
  buffer_store_dwordx4 v[48:51], v21, s[12:15], s39 offen sc1
  s_lshl_b32 s39, s89, 10
  s_add_u32 s89, s89, 128
  s_waitcnt vmcnt(9)
  buffer_store_dwordx4 v[52:55], v21, s[12:15], s39 offen sc1
  s_lshl_b32 s39, s89, 10
  s_add_u32 s89, s89, 128
  s_waitcnt vmcnt(9)
  buffer_store_dwordx4 v[56:59], v21, s[12:15], s39 offen sc1
  s_lshl_b32 s39, s89, 10
  s_add_u32 s89, s89, 128
  s_waitcnt vmcnt(9)
  buffer_store_dwordx4 v[60:63], v21, s[12:15], s39 offen sc1
  s_mov_b32 s16, s52
  s_and_b32 s17, s53, 0xffff
  s_mov_b32 s18, 0x21c000
  s_mov_b32 s19, 0x20000
  v_mov_b32 v4, 0
  buffer_load_dwordx2 v[8:9], v4, s[24:27], 0 offen sc1
  s_waitcnt vmcnt(0)
  s_mov_b32 s86, 0
L_tag_20:
  v_readfirstlane_b32 s90, v8
  v_readfirstlane_b32 s91, v9
  s_add_u32 s86, s86, 1
  s_cmp_lg_u32 s90, 0
  s_cbranch_scc1 L_tagd_21
  s_cmp_ge_u32 s86, 0x40000
  s_cbranch_scc1 L_tagd_21
  s_sleep 2
  v_mov_b32 v4, 0
  buffer_load_dwordx2 v[8:9], v4, s[24:27], 0 offen sc1
  s_waitcnt vmcnt(0)
  s_branch L_tag_20
L_tagd_21:
  s_barrier
  s_cmp_lg_u32 s20, 0
  s_cbranch_scc1 L_sig_22
  s_add_u32 s16, s60, 0x1a00000
  s_addc_u32 s17, s61, 0
  s_and_b32 s17, s17, 0xffff
  s_mov_b32 s18, 0x2000
  s_mov_b32 s19, 0x20000
  s_lshl_b32 s39, s21, 7
  s_lshl_b32 s40, s22, 3
  s_add_u32 s39, s39, s40
  v_mov_b32 v4, 0
  v_mov_b32 v12, s90
  v_mov_b32 v13, s91
  s_mov_b64 exec, 1
  buffer_store_dwordx2 v[12:13], v4, s[16:19], s39 offen sc1
  s_mov_b64 exec, -1
L_sig_22:
L_p2_7:
  s_and_b32 s39, s2, 7
  s_lshl_b32 s21, s39, 1
  s_bfe_u32 s39, s2, 0x10003
  s_add_u32 s21, s21, s39
  s_lshr_b32 s22, s2, 4
  s_and_b32 s74, s20, 1
  s_lshr_b32 s39, s20, 1
  s_lshl_b32 s39, s39, 5
  s_lshl_b32 s28, s21, 7
  s_sub_u32 s29, s28, 256
  s_add_u32 s28, s28, s39
  v_lshlrev_b32 v20, 4, v1
  v_mov_b32 v36, 0x3f803f80
  v_mov_b32 v37, v36
  v_mov_b32 v38, v36
  v_mov_b32 v39, v36
  v_lshlrev_b32 v4, 4, v0
  ds_write_b128 v4, v[36:39] offset:62080
  s_mov_b32 s4, s60
  s_and_b32 s5, s61, 0xffff
  s_mov_b32 s6, 0x780000
  s_mov_b32 s7, 0x20000
  s_add_u32 s12, s60, 0x800000
  s_addc_u32 s13, s61, 0
  s_and_b32 s13, s13, 0xffff
  s_mov_b32 s14, 0x280000
  s_mov_b32 s15, 0x20000
  s_add_u32 s39, s20, 0
  s_min_u32 s39, s39, 29
  s_mul_i32 s40, s39, 43
  s_lshr_b32 s40, s40, 8
  s_mul_i32 s41, s40, 6
  s_sub_u32 s41, s39, s41
  s_mul_i32 s42, s22, 5
  s_add_u32 s42, s42, s40
  s_add_u32 s42, s42, 80
  s_mul_i32 s42, s42, 32768
  s_lshl_b32 s43, s41, 6
  s_add_u32 s43, s43, s29
  s_lshl_b32 s43, s43, 4
  s_add_u32 s62, s42, s43
  s_lshl_b32 s66, s39, 10
  s_lshl_b32 s40, s40, 7
  s_add_u32 s70, s66, s40
  s_add_u32 s70, s70, 30720
  s_add_u32 s39, s20, 8
  s_min_u32 s39, s39, 29
  s_mul_i32 s40, s39, 43
  s_lshr_b32 s40, s40, 8
  s_mul_i32 s41, s40, 6
  s_sub_u32 s41, s39, s41
  s_mul_i32 s42, s22, 5
  s_add_u32 s42, s42, s40
  s_add_u32 s42, s42, 80
  s_mul_i32 s42, s42, 32768
  s_lshl_b32 s43, s41, 6
  s_add_u32 s43, s43, s29
  s_lshl_b32 s43, s43, 4
  s_add_u32 s63, s42, s43
  s_lshl_b32 s67, s39, 10
  s_lshl_b32 s40, s40, 7
  s_add_u32 s71, s67, s40
  s_add_u32 s71, s71, 30720
  s_add_u32 s39, s20, 16
  s_min_u32 s39, s39, 29
  s_mul_i32 s40, s39, 43
  s_lshr_b32 s40, s40, 8
  s_mul_i32 s41, s40, 6
  s_sub_u32 s41, s39, s41
  s_mul_i32 s42, s22, 5
  s_add_u32 s42, s42, s40
  s_add_u32 s42, s42, 80
  s_mul_i32 s42, s42, 32768
  s_lshl_b32 s43, s41, 6
  s_add_u32 s43, s43, s29
  s_lshl_b32 s43, s43, 4
  s_add_u32 s64, s42, s43
  s_lshl_b32 s68, s39, 10
  s_lshl_b32 s40, s40, 7
  s_add_u32 s72, s68, s40
  s_add_u32 s72, s72, 30720
  s_add_u32 s39, s20, 24
  s_min_u32 s39, s39, 29
  s_mul_i32 s40, s39, 43
  s_lshr_b32 s40, s40, 8
  s_mul_i32 s41, s40, 6
  s_sub_u32 s41, s39, s41
  s_mul_i32 s42, s22, 5
  s_add_u32 s42, s42, s40
  s_add_u32 s42, s42, 80
  s_mul_i32 s42, s42, 32768
  s_lshl_b32 s43, s41, 6
  s_add_u32 s43, s43, s29
  s_lshl_b32 s43, s43, 4
  s_add_u32 s65, s42, s43
  s_lshl_b32 s69, s39, 10
  s_lshl_b32 s40, s40, 7
  s_add_u32 s73, s69, s40
  s_add_u32 s73, s73, 30720
  v_cmp_eq_u32 vcc, 2, v2
  v_and_b32 v4, 1, v2
  s_mul_i32 s39, s74, 3
  v_add_u32 v4, s39, v4
  v_cndmask_b32 v4, v4, 2, vcc
  v_mul_u32_u24 v21, 6144, v4
  s_mul_i32 s39, s22, 5
  v_add_u32 v4, s39, v4
  v_mul_u32_u24 v4, 32768, v4
  v_add_u32 v5, s28, v3
  v_lshl_add_u32 v26, v5, 4, v4
  s_lshr_b32 s39, s20, 1
  s_lshl_b32 s39, s39, 9
  v_lshl_add_u32 v21, v3, 4, v21
  v_add_u32 v21, s39, v21
  v_lshrrev_b32 v4, 2, v3
  v_lshl_add_u32 v4, v2, 2, v4
  v_lshlrev_b32 v4, 4, v4
  v_add_u32 v4, s39, v4
  v_add_u32 v4, 30720, v4
  v_and_b32 v5, 3, v3
  s_mul_i32 s39, s74, 5
  v_add_u32 v6, s39, v5
  v_lshrrev_b32 v22, 1, v6
  v_mul_u32_u24 v22, 6272, v22
  v_and_b32 v6, 1, v6
  v_lshl_add_u32 v22, v6, 3, v22
  v_add_u32 v22, v22, v4
  s_add_u32 s39, s39, 4
  v_mov_b32 v6, s39
  v_cmp_eq_u32 vcc, 0, v5
  s_nop 1
  v_cndmask_b32 v6, 10, v6, vcc
  v_lshrrev_b32 v23, 1, v6
  v_mul_u32_u24 v23, 6272, v23
  v_and_b32 v6, 1, v6
  v_lshl_add_u32 v23, v6, 3, v23
  v_add_u32 v23, v23, v4
  s_mul_i32 s39, s22, 10
  s_mul_i32 s40, s74, 5
  s_add_u32 s39, s39, s40
  v_add_u32 v4, s39, v2
  v_add_u32 v4, s40, v2
  s_lshr_b32 s39, s20, 1
  s_lshl_b32 s39, s39, 9
  s_add_u32 s39, s39, 81920
  v_lshl_add_u32 v6, v3, 4, s39
  v_lshrrev_b32 v24, 1, v4
  v_lshlrev_b32 v24, 11, v24
  v_and_b32 v4, 1, v4
  v_lshl_add_u32 v24, v4, 3, v24
  v_add_u32 v24, v24, v6
  s_add_u32 s39, s40, 4
  s_lshr_b32 s40, s39, 1
  s_lshl_b32 s40, s40, 11
  s_and_b32 s39, s39, 1
  s_lshl_b32 s39, s39, 3
  s_add_u32 s39, s39, s40
  v_add_u32 v25, s39, v6
  v_add_u32 v4, 10240, v6
  v_cmp_eq_u32 vcc, 0, v2
  s_nop 1
  v_cndmask_b32 v25, v4, v25, vcc
  v_mov_b32 v4, 0xf149f2ca
  v_lshlrev_b32 v5, 2, v2
  v_add_u32 v6, 0, v5
  v_cmp_le_u32 vcc, v6, v3
  s_nop 1
  v_cndmask_b32 v48, v4, 0, vcc
  v_cndmask_b32 v52, 0, v4, vcc
  v_add_u32 v6, 1, v5
  v_cmp_le_u32 vcc, v6, v3
  s_nop 1
  v_cndmask_b32 v49, v4, 0, vcc
  v_cndmask_b32 v53, 0, v4, vcc
  v_add_u32 v6, 2, v5
  v_cmp_le_u32 vcc, v6, v3
  s_nop 1
  v_cndmask_b32 v50, v4, 0, vcc
  v_cndmask_b32 v54, 0, v4, vcc
  v_add_u32 v6, 3, v5
  v_cmp_le_u32 vcc, v6, v3
  s_nop 1
  v_cndmask_b32 v51, v4, 0, vcc
  v_cndmask_b32 v55, 0, v4, vcc
  s_sub_i32 s30, 256, s28
  s_max_i32 s30, s30, 0
  s_lshr_b32 s30, s30, 4
  v_mov_b32 v72, 0
  v_mov_b32 v73, 0
  v_mov_b32 v74, 0
  v_mov_b32 v75, 0
  v_mov_b32 v76, 0
  v_mov_b32 v77, 0
  v_mov_b32 v78, 0
  v_mov_b32 v79, 0
  v_mov_b32 v80, 0
  v_mov_b32 v81, 0
  v_mov_b32 v82, 0
  v_mov_b32 v83, 0
  v_mov_b32 v84, 0
  v_mov_b32 v85, 0
  v_mov_b32 v86, 0
  v_mov_b32 v87, 0
  s_sub_u32 s39, 3, s74
  s_add_u32 s40, s74, 2
  v_cmp_le_u32 s[78:79], s39, v2
  v_cmp_le_u32 s[80:81], s40, v2
  s_add_u32 s8, s60, 0x1600000
  s_addc_u32 s9, s61, 0
  s_and_b32 s9, s9, 0xffff
  s_mov_b32 s10, 0x2e4000
  s_mov_b32 s11, 0x20000
  v_lshlrev_b32 v93, 4, v1
  s_mov_b32 s89, 0x100000
  s_cmp_eq_u32 s20, 0
  s_cbranch_scc1 L_norl_23
  s_mov_b32 s82, s30
  s_mov_b32 s88, 819200
  s_mul_i32 s30, s2, 7
  s_add_u32 s30, s30, s20
  s_add_u32 s30, s30, 1279
  s_mov_b32 s89, s30
  s_mov_b32 s87, 0x1999999a
  v_lshlrev_b32 v93, 4, v1
  s_cmp_ge_u32 s30, 800
  s_cselect_b32 s4, s54, s48
  s_cselect_b32 s5, s55, s49
  s_cselect_b32 s6, 2211840, s88
  s_cselect_b32 s43, 800, 0
  s_cselect_b32 s31, 27, 10
  s_cselect_b32 s32, 0x97b425f, s87
  s_and_b32 s5, s5, 0xffff
  s_sub_u32 s43, s30, s43
  s_mul_hi_u32 s39, s43, s87
  s_mul_i32 s40, s39, 10
  s_sub_u32 s40, s43, s40
  s_mul_hi_u32 s41, s39, s32
  s_mul_i32 s42, s41, s31
  s_sub_u32 s42, s39, s42
  s_lshl_b32 s40, s40, 6
  v_add_u32 v4, s40, v1
  v_mul_hi_u32 v5, v4, s87
  v_mul_u32_u24 v6, 10, v5
  v_sub_u32 v4, v4, v6
  v_lshlrev_b32 v4, 4, v4
  v_and_b32 v92, 0x23, v5
  v_bfe_u32 v6, v5, 2, 2
  v_lshl_add_u32 v92, v6, 3, v92
  v_bfe_u32 v6, v5, 4, 1
  v_lshl_add_u32 v92, v6, 2, v92
  v_mul_u32_u24 v92, 1280, v92
  v_add_u32 v92, v92, v4
  s_mul_i32 s42, s42, 81920
  s_mul_i32 s41, s41, 160
  s_add_u32 s42, s42, s41
  buffer_load_dwordx4 v[100:103], v92, s[4:7], s42 offen
  s_add_u32 s30, s30, 1
  s_mov_b32 s30, s82
  s_mov_b32 s4, s60
  s_and_b32 s5, s61, 0xffff
  s_mov_b32 s6, 0x780000
  s_mov_b32 s7, 0x20000
L_norl_23:
  s_cmp_lg_u32 s20, 0
  s_cbranch_scc1 L_pskip_24
  s_add_u32 s16, s60, 0x1a00000
  s_addc_u32 s17, s61, 0
  s_and_b32 s17, s17, 0xffff
  s_mov_b32 s18, 0x2000
  s_mov_b32 s19, 0x20000
  s_mov_b32 s39, 0x2aaaaaab
  v_mul_hi_u32 v4, v1, s39
  v_mul_u32_u24 v5, 6, v4
  v_sub_u32 v5, v1, v5
  v_cmp_gt_u32 vcc, 2, v5
  v_lshrrev_b32 v6, 1, v5
  v_and_b32 v5, 1, v5
  v_cndmask_b32 v4, v4, 0, vcc
  v_sub_u32 v4, s21, v4
  v_max_i32 v4, 0, v4
  v_lshlrev_b32 v4, 7, v4
  s_mul_i32 s39, s22, 40
  v_mul_u32_u24 v5, 39, v5
  v_add_u32 v5, s39, v5
  v_lshrrev_b32 v5, 7, v5
  v_mad_u32_u24 v5, v6, 5, v5
  v_lshl_add_u32 v4, v5, 3, v4
  s_mov_b32 exec_lo, 0x3ffff
  s_mov_b32 exec_hi, 0x0
  s_mov_b32 s86, 0
L_poll_25:
  buffer_load_dwordx2 v[12:13], v4, s[16:19], 0 offen sc1
  s_waitcnt vmcnt(0)
  v_xor_b32 v12, s90, v12
  v_xor_b32 v13, s91, v13
  v_or_b32 v12, v12, v13
  v_cmp_eq_u32 vcc, 0, v12
  s_add_u32 s86, s86, 1
  s_cmp_eq_u64 vcc, exec
  s_cbranch_scc1 L_pdone_26
  s_sleep 4
  s_cmp_lt_u32 s86, 0x40000
  s_cbranch_scc1 L_poll_25
L_pdone_26:
  s_mov_b64 exec, -1
L_pskip_24:
  s_waitcnt lgkmcnt(0)
  s_barrier
  s_mov_b32 m0, s66
  s_nop 0
  buffer_load_dwordx4 v20, s[4:7], s62 offen sc1 lds
  s_mov_b32 m0, s67
  s_nop 0
  buffer_load_dwordx4 v20, s[4:7], s63 offen sc1 lds
  s_mov_b32 m0, s68
  s_nop 0
  buffer_load_dwordx4 v20, s[4:7], s64 offen sc1 lds
  s_mov_b32 m0, s69
  s_nop 0
  buffer_load_dwordx4 v20, s[4:7], s65 offen sc1 lds
  buffer_load_dwordx4 v[28:31], v26, s[4:7], 0 offen sc1
  buffer_load_dwordx4 v[32:35], v26, s[4:7], 0 offen offset:256 sc1
  v_add_u32 v20, 0x280000, v20
  s_waitcnt vmcnt(0)
  s_cmp_eq_u32 s20, 0
  s_cbranch_scc1 L_nors_27
  s_lshl_b32 s39, s89, 10
  buffer_store_dwordx4 v[100:103], v93, s[8:11], s39 offen sc1
L_nors_27:
  s_mov_b32 m0, s70
  s_nop 0
  buffer_load_dwordx4 v20, s[4:7], s62 offen sc1 lds
  s_mov_b32 m0, s71
  s_nop 0
  buffer_load_dwordx4 v20, s[4:7], s63 offen sc1 lds
  s_mov_b32 m0, s72
  s_nop 0
  buffer_load_dwordx4 v20, s[4:7], s64 offen sc1 lds
  s_mov_b32 m0, s73
  s_nop 0
  buffer_load_dwordx4 v20, s[4:7], s65 offen sc1 lds
  v_cndmask_b32 v28, v28, 0, s[78:79]
  v_cndmask_b32 v29, v29, 0, s[78:79]
  v_cndmask_b32 v30, v30, 0, s[80:81]
  v_cndmask_b32 v31, v31, 0, s[80:81]
  v_cndmask_b32 v32, v32, 0, s[78:79]
  v_cndmask_b32 v33, v33, 0, s[78:79]
  v_cndmask_b32 v34, v34, 0, s[80:81]
  v_cndmask_b32 v35, v35, 0, s[80:81]
  s_barrier
  ds_read_b128 v[36:39], v21
  ds_read_b128 v[40:43], v21 offset:256
  ds_read_b128 v[44:47], v21 offset:512
  s_waitcnt lgkmcnt(2)
  s_cmp_gt_u32 s30, 0
  s_cbranch_scc1 L_skip_28
  v_mfma_f32_16x16x32_bf16 v[104:107], v[36:39], v[28:31], v[52:55]
L_back_29:
  ds_read_b128 v[36:39], v21 offset:768
  s_waitcnt lgkmcnt(2)
  s_cmp_gt_u32 s30, 1
  s_cbranch_scc1 L_skip_30
  v_mfma_f32_16x16x32_bf16 v[112:115], v[40:43], v[28:31], 0
  v_mfma_f32_16x16x32_bf16 v[116:119], v[40:43], v[32:35], v[52:55]
L_back_31:
  ds_read_b128 v[40:43], v21 offset:1024
  s_waitcnt lgkmcnt(2)
  s_cmp_gt_u32 s30, 2
  s_cbranch_scc1 L_skip_32
  v_mfma_f32_16x16x32_bf16 v[120:123], v[44:47], v[28:31], 0
  v_mfma_f32_16x16x32_bf16 v[124:127], v[44:47], v[32:35], 0
L_back_33:
  v_max3_f32 v88, v104, v105, v106
  v_max_f32 v88, v88, v107
  ds_read_b128 v[44:47], v21 offset:1280
  s_waitcnt lgkmcnt(2)
  s_cmp_gt_u32 s30, 3
  s_cbranch_scc1 L_skip_34
  v_mfma_f32_16x16x32_bf16 v[128:131], v[36:39], v[28:31], 0
  v_mfma_f32_16x16x32_bf16 v[132:135], v[36:39], v[32:35], 0
L_back_35:
  v_max3_f32 v88, v88, v112, v113
  v_max3_f32 v88, v88, v114, v115
  v_max3_f32 v90, v116, v117, v118
  v_max_f32 v90, v90, v119
  ds_read_b128 v[36:39], v21 offset:1536
  s_waitcnt lgkmcnt(2)
  s_cmp_gt_u32 s30, 4
  s_cbranch_scc1 L_skip_36
  v_mfma_f32_16x16x32_bf16 v[136:139], v[40:43], v[28:31], 0
  v_mfma_f32_16x16x32_bf16 v[140:143], v[40:43], v[32:35], 0
L_back_37:
  v_max3_f32 v88, v88, v120, v121
  v_max3_f32 v88, v88, v122, v123
  v_max3_f32 v90, v90, v124, v125
  v_max3_f32 v90, v90, v126, v127
  ds_read_b128 v[40:43], v21 offset:1792
  s_waitcnt lgkmcnt(2)
  s_cmp_gt_u32 s30, 5
  s_cbranch_scc1 L_skip_38
  v_mfma_f32_16x16x32_bf16 v[144:147], v[44:47], v[28:31], 0
  v_mfma_f32_16x16x32_bf16 v[148:151], v[44:47], v[32:35], 0
L_back_39:
  v_max3_f32 v88, v88, v128, v129
  v_max3_f32 v88, v88, v130, v131
  v_max3_f32 v90, v90, v132, v133
  v_max3_f32 v90, v90, v134, v135
  ds_read_b128 v[44:47], v21 offset:2048
  s_waitcnt lgkmcnt(2)
  s_cmp_gt_u32 s30, 6
  s_cbranch_scc1 L_skip_40
  v_mfma_f32_16x16x32_bf16 v[152:155], v[36:39], v[28:31], 0
  v_mfma_f32_16x16x32_bf16 v[156:159], v[36:39], v[32:35], 0
L_back_41:
  v_max3_f32 v88, v88, v136, v137
  v_max3_f32 v88, v88, v138, v139
  v_max3_f32 v90, v90, v140, v141
  v_max3_f32 v90, v90, v142, v143
  ds_read_b128 v[36:39], v21 offset:2304
  s_waitcnt lgkmcnt(2)
  s_cmp_gt_u32 s30, 7
  s_cbranch_scc1 L_skip_42
  v_mfma_f32_16x16x32_bf16 v[160:163], v[40:43], v[28:31], 0
  v_mfma_f32_16x16x32_bf16 v[164:167], v[40:43], v[32:35], 0
L_back_43:
  v_max3_f32 v88, v88, v144, v145
  v_max3_f32 v88, v88, v146, v147
  v_max3_f32 v90, v90, v148, v149
  v_max3_f32 v90, v90, v150, v151
  ds_read_b128 v[40:43], v21 offset:2560
  s_waitcnt lgkmcnt(2)
  s_cmp_gt_u32 s30, 8
  s_cbranch_scc1 L_skip_44
  v_mfma_f32_16x16x32_bf16 v[168:171], v[44:47], v[28:31], 0
  v_mfma_f32_16x16x32_bf16 v[172:175], v[44:47], v[32:35], 0
L_back_45:
  v_max3_f32 v88, v88, v152, v153
  v_max3_f32 v88, v88, v154, v155
  v_max3_f32 v90, v90, v156, v157
  v_max3_f32 v90, v90, v158, v159
  ds_read_b128 v[44:47], v21 offset:2816
  s_waitcnt lgkmcnt(2)
  s_cmp_gt_u32 s30, 9
  s_cbranch_scc1 L_skip_46
  v_mfma_f32_16x16x32_bf16 v[176:179], v[36:39], v[28:31], 0
  v_mfma_f32_16x16x32_bf16 v[180:183], v[36:39], v[32:35], 0
L_back_47:
  v_max3_f32 v88, v88, v160, v161
  v_max3_f32 v88, v88, v162, v163
  v_max3_f32 v90, v90, v164, v165
  v_max3_f32 v90, v90, v166, v167
  ds_read_b128 v[36:39], v21 offset:3072
  s_waitcnt lgkmcnt(2)
  s_cmp_gt_u32 s30, 10
  s_cbranch_scc1 L_skip_48
  v_mfma_f32_16x16x32_bf16 v[184:187], v[40:43], v[28:31], 0
  v_mfma_f32_16x16x32_bf16 v[188:191], v[40:43], v[32:35], 0
L_back_49:
  v_max3_f32 v88, v88, v168, v169
  v_max3_f32 v88, v88, v170, v171
  v_max3_f32 v90, v90, v172, v173
  v_max3_f32 v90, v90, v174, v175
  ds_read_b128 v[40:43], v21 offset:3328
  s_waitcnt lgkmcnt(2)
  s_cmp_gt_u32 s30, 11
  s_cbranch_scc1 L_skip_50
  v_mfma_f32_16x16x32_bf16 v[192:195], v[44:47], v[28:31], 0
  v_mfma_f32_16x16x32_bf16 v[196:199], v[44:47], v[32:35], 0
L_back_51:
  v_max3_f32 v88, v88, v176, v177
  v_max3_f32 v88, v88, v178, v179
  v_max3_f32 v90, v90, v180, v181
  v_max3_f32 v90, v90, v182, v183
  ds_read_b128 v[44:47], v21 offset:3584
  s_waitcnt lgkmcnt(2)
  s_cmp_gt_u32 s30, 12
  s_cbranch_scc1 L_skip_52
  v_mfma_f32_16x16x32_bf16 v[200:203], v[36:39], v[28:31], 0
  v_mfma_f32_16x16x32_bf16 v[204:207], v[36:39], v[32:35], 0
L_back_53:
  v_max3_f32 v88, v88, v184, v185
  v_max3_f32 v88, v88, v186, v187
  v_max3_f32 v90, v90, v188, v189
  v_max3_f32 v90, v90, v190, v191
  ds_read_b128 v[36:39], v21 offset:3840
  s_waitcnt lgkmcnt(2)
  s_cmp_gt_u32 s30, 13
  s_cbranch_scc1 L_skip_54
  v_mfma_f32_16x16x32_bf16 v[208:211], v[40:43], v[28:31], 0
  v_mfma_f32_16x16x32_bf16 v[212:215], v[40:43], v[32:35], 0
L_back_55:
  v_max3_f32 v88, v88, v192, v193
  v_max3_f32 v88, v88, v194, v195
  v_max3_f32 v90, v90, v196, v197
  v_max3_f32 v90, v90, v198, v199
  ds_read_b128 v[40:43], v21 offset:4096
  s_waitcnt lgkmcnt(2)
  s_cmp_gt_u32 s30, 14
  s_cbranch_scc1 L_skip_56
  v_mfma_f32_16x16x32_bf16 v[216:219], v[44:47], v[28:31], 0
  v_mfma_f32_16x16x32_bf16 v[220:223], v[44:47], v[32:35], 0
L_back_57:
  v_max3_f32 v88, v88, v200, v201
  v_max3_f32 v88, v88, v202, v203
  v_max3_f32 v90, v90, v204, v205
  v_max3_f32 v90, v90, v206, v207
  ds_read_b128 v[44:47], v21 offset:4352
  s_waitcnt lgkmcnt(2)
  s_cmp_gt_u32 s30, 15
  s_cbranch_scc1 L_skip_58
  v_mfma_f32_16x16x32_bf16 v[224:227], v[36:39], v[28:31], 0
  v_mfma_f32_16x16x32_bf16 v[228:231], v[36:39], v[32:35], 0
L_back_59:
  v_max3_f32 v88, v88, v208, v209
  v_max3_f32 v88, v88, v210, v211
  v_max3_f32 v90, v90, v212, v213
  v_max3_f32 v90, v90, v214, v215
  s_waitcnt lgkmcnt(1)
  v_mfma_f32_16x16x32_bf16 v[232:235], v[40:43], v[28:31], v[48:51]
  v_mfma_f32_16x16x32_bf16 v[236:239], v[40:43], v[32:35], 0
  v_max3_f32 v88, v88, v216, v217
  v_max3_f32 v88, v88, v218, v219
  v_max3_f32 v90, v90, v220, v221
  v_max3_f32 v90, v90, v222, v223
  s_waitcnt lgkmcnt(0)
  v_mfma_f32_16x16x32_bf16 v[244:247], v[44:47], v[32:35], v[48:51]
  v_max3_f32 v88, v88, v224, v225
  v_max3_f32 v88, v88, v226, v227
  v_max3_f32 v90, v90, v228, v229
  v_max3_f32 v90, v90, v230, v231
  s_nop 3
  v_max3_f32 v88, v88, v232, v233
  v_max3_f32 v88, v88, v234, v235
  v_max3_f32 v90, v90, v236, v237
  v_max3_f32 v90, v90, v238, v239
  s_nop 3
  v_max3_f32 v90, v90, v244, v245
  v_max3_f32 v90, v90, v246, v247
  v_mov_b32 v4, v88
  s_nop 1
  v_permlane32_swap_b32 v88, v4
  s_nop 0
  v_max_f32 v88, v88, v4
  v_mov_b32 v4, v88
  s_nop 1
  v_permlane16_swap_b32 v88, v4
  s_nop 0
  v_max_f32 v88, v88, v4
  v_mov_b32 v4, v90
  s_nop 1
  v_permlane32_swap_b32 v90, v4
  s_nop 0
  v_max_f32 v90, v90, v4
  v_mov_b32 v4, v90
  s_nop 1
  v_permlane16_swap_b32 v90, v4
  s_nop 0
  v_max_f32 v90, v90, v4
  s_waitcnt vmcnt(0)
  s_barrier
  ds_read_b64_tr_b16 v[56:57], v22 offset:0
  ds_read_b64_tr_b16 v[58:59], v22 offset:256
  ds_read_b64_tr_b16 v[60:61], v23 offset:0
  ds_read_b64_tr_b16 v[62:63], v23 offset:256
  ds_read_b64_tr_b16 v[64:65], v22 offset:512
  ds_read_b64_tr_b16 v[66:67], v22 offset:768
  ds_read_b64_tr_b16 v[68:69], v23 offset:512
  ds_read_b64_tr_b16 v[70:71], v23 offset:768
  v_pk_add_f32 v[104:105], v[104:105], v[88:89] op_sel_hi:[1,0] neg_lo:[0,1] neg_hi:[0,1]
  v_pk_add_f32 v[106:107], v[106:107], v[88:89] op_sel_hi:[1,0] neg_lo:[0,1] neg_hi:[0,1]
  v_exp_f32 v104, v104
  v_exp_f32 v105, v105
  v_exp_f32 v106, v106
  v_exp_f32 v107, v107
  v_pk_add_f32 v[112:113], v[112:113], v[88:89] op_sel_hi:[1,0] neg_lo:[0,1] neg_hi:[0,1]
  v_pk_add_f32 v[114:115], v[114:115], v[88:89] op_sel_hi:[1,0] neg_lo:[0,1] neg_hi:[0,1]
  v_exp_f32 v112, v112
  v_exp_f32 v113, v113
  v_exp_f32 v114, v114
  v_exp_f32 v115, v115
  s_nop 0
  v_cvt_pk_bf16_f32 v104, v104, v105
  v_cvt_pk_bf16_f32 v105, v106, v107
  v_cvt_pk_bf16_f32 v106, v112, v113
  v_cvt_pk_bf16_f32 v107, v114, v115
  v_pk_add_f32 v[116:117], v[116:117], v[90:91] op_sel_hi:[1,0] neg_lo:[0,1] neg_hi:[0,1]
  v_pk_add_f32 v[118:119], v[118:119], v[90:91] op_sel_hi:[1,0] neg_lo:[0,1] neg_hi:[0,1]
  v_exp_f32 v116, v116
  v_exp_f32 v117, v117
  v_exp_f32 v118, v118
  v_exp_f32 v119, v119
  s_nop 0
  v_mov_b32 v108, 0
  v_mov_b32 v109, 0
  v_cvt_pk_bf16_f32 v110, v116, v117
  v_cvt_pk_bf16_f32 v111, v118, v119
  s_waitcnt lgkmcnt(4)
  v_mfma_f32_16x16x32_bf16 v[72:75], v[56:59], v[104:107], v[72:75]
  v_mfma_f32_16x16x32_bf16 v[76:79], v[60:63], v[104:107], v[76:79]
  v_mfma_f32_16x16x32_bf16 v[80:83], v[56:59], v[108:111], v[80:83]
  v_mfma_f32_16x16x32_bf16 v[84:87], v[60:63], v[108:111], v[84:87]
  ds_read_b64_tr_b16 v[56:57], v22 offset:1024
  ds_read_b64_tr_b16 v[58:59], v22 offset:1280
  ds_read_b64_tr_b16 v[60:61], v23 offset:1024
  ds_read_b64_tr_b16 v[62:63], v23 offset:1280
  v_pk_add_f32 v[120:121], v[120:121], v[88:89] op_sel_hi:[1,0] neg_lo:[0,1] neg_hi:[0,1]
  v_pk_add_f32 v[122:123], v[122:123], v[88:89] op_sel_hi:[1,0] neg_lo:[0,1] neg_hi:[0,1]
  v_exp_f32 v120, v120
  v_exp_f32 v121, v121
  v_exp_f32 v122, v122
  v_exp_f32 v123, v123
  v_pk_add_f32 v[128:129], v[128:129], v[88:89] op_sel_hi:[1,0] neg_lo:[0,1] neg_hi:[0,1]
  v_pk_add_f32 v[130:131], v[130:131], v[88:89] op_sel_hi:[1,0] neg_lo:[0,1] neg_hi:[0,1]
  v_exp_f32 v128, v128
  v_exp_f32 v129, v129
  v_exp_f32 v130, v130
  v_exp_f32 v131, v131
  s_nop 0
  v_cvt_pk_bf16_f32 v120, v120, v121
  v_cvt_pk_bf16_f32 v121, v122, v123
  v_cvt_pk_bf16_f32 v122, v128, v129
  v_cvt_pk_bf16_f32 v123, v130, v131
  v_pk_add_f32 v[124:125], v[124:125], v[90:91] op_sel_hi:[1,0] neg_lo:[0,1] neg_hi:[0,1]
  v_pk_add_f32 v[126:127], v[126:127], v[90:91] op_sel_hi:[1,0] neg_lo:[0,1] neg_hi:[0,1]
  v_exp_f32 v124, v124
  v_exp_f32 v125, v125
  v_exp_f32 v126, v126
  v_exp_f32 v127, v127
  v_pk_add_f32 v[132:133], v[132:133], v[90:91] op_sel_hi:[1,0] neg_lo:[0,1] neg_hi:[0,1]
  v_pk_add_f32 v[134:135], v[134:135], v[90:91] op_sel_hi:[1,0] neg_lo:[0,1] neg_hi:[0,1]
  v_exp_f32 v132, v132
  v_exp_f32 v133, v133
  v_exp_f32 v134, v134
  v_exp_f32 v135, v135
  s_nop 0
  v_cvt_pk_bf16_f32 v124, v124, v125
  v_cvt_pk_bf16_f32 v125, v126, v127
  v_cvt_pk_bf16_f32 v126, v132, v133
  v_cvt_pk_bf16_f32 v127, v134, v135
  s_waitcnt lgkmcnt(4)
  v_mfma_f32_16x16x32_bf16 v[72:75], v[64:67], v[120:123], v[72:75]
  v_mfma_f32_16x16x32_bf16 v[76:79], v[68:71], v[120:123], v[76:79]
  v_mfma_f32_16x16x32_bf16 v[80:83], v[64:67], v[124:127], v[80:83]
  v_mfma_f32_16x16x32_bf16 v[84:87], v[68:71], v[124:127], v[84:87]
  ds_read_b64_tr_b16 v[64:65], v22 offset:1536
  ds_read_b64_tr_b16 v[66:67], v22 offset:1792
  ds_read_b64_tr_b16 v[68:69], v23 offset:1536
  ds_read_b64_tr_b16 v[70:71], v23 offset:1792
  v_pk_add_f32 v[136:137], v[136:137], v[88:89] op_sel_hi:[1,0] neg_lo:[0,1] neg_hi:[0,1]
  v_pk_add_f32 v[138:139], v[138:139], v[88:89] op_sel_hi:[1,0] neg_lo:[0,1] neg_hi:[0,1]
  v_exp_f32 v136, v136
  v_exp_f32 v137, v137
  v_exp_f32 v138, v138
  v_exp_f32 v139, v139
  v_pk_add_f32 v[144:145], v[144:145], v[88:89] op_sel_hi:[1,0] neg_lo:[0,1] neg_hi:[0,1]
  v_pk_add_f32 v[146:147], v[146:147], v[88:89] op_sel_hi:[1,0] neg_lo:[0,1] neg_hi:[0,1]
  v_exp_f32 v144, v144
  v_exp_f32 v145, v145
  v_exp_f32 v146, v146
  v_exp_f32 v147, v147
  s_nop 0
  v_cvt_pk_bf16_f32 v136, v136, v137
  v_cvt_pk_bf16_f32 v137, v138, v139
  v_cvt_pk_bf16_f32 v138, v144, v145
  v_cvt_pk_bf16_f32 v139, v146, v147
  v_pk_add_f32 v[140:141], v[140:141], v[90:91] op_sel_hi:[1,0] neg_lo:[0,1] neg_hi:[0,1]
  v_pk_add_f32 v[142:143], v[142:143], v[90:91] op_sel_hi:[1,0] neg_lo:[0,1] neg_hi:[0,1]
  v_exp_f32 v140, v140
  v_exp_f32 v141, v141
  v_exp_f32 v142, v142
  v_exp_f32 v143, v143
  v_pk_add_f32 v[148:149], v[148:149], v[90:91] op_sel_hi:[1,0] neg_lo:[0,1] neg_hi:[0,1]
  v_pk_add_f32 v[150:151], v[150:151], v[90:91] op_sel_hi:[1,0] neg_lo:[0,1] neg_hi:[0,1]
  v_exp_f32 v148, v148
  v_exp_f32 v149, v149
  v_exp_f32 v150, v150
  v_exp_f32 v151, v151
  s_nop 0
  v_cvt_pk_bf16_f32 v140, v140, v141
  v_cvt_pk_bf16_f32 v141, v142, v143
  v_cvt_pk_bf16_f32 v142, v148, v149
  v_cvt_pk_bf16_f32 v143, v150, v151
  s_waitcnt lgkmcnt(4)
  v_mfma_f32_16x16x32_bf16 v[72:75], v[56:59], v[136:139], v[72:75]
  v_mfma_f32_16x16x32_bf16 v[76:79], v[60:63], v[136:139], v[76:79]
  v_mfma_f32_16x16x32_bf16 v[80:83], v[56:59], v[140:143], v[80:83]
  v_mfma_f32_16x16x32_bf16 v[84:87], v[60:63], v[140:143], v[84:87]
  ds_read_b64_tr_b16 v[56:57], v22 offset:2048
  ds_read_b64_tr_b16 v[58:59], v22 offset:2304
  ds_read_b64_tr_b16 v[60:61], v23 offset:2048
  ds_read_b64_tr_b16 v[62:63], v23 offset:2304
  v_pk_add_f32 v[152:153], v[152:153], v[88:89] op_sel_hi:[1,0] neg_lo:[0,1] neg_hi:[0,1]
  v_pk_add_f32 v[154:155], v[154:155], v[88:89] op_sel_hi:[1,0] neg_lo:[0,1] neg_hi:[0,1]
  v_exp_f32 v152, v152
  v_exp_f32 v153, v153
  v_exp_f32 v154, v154
  v_exp_f32 v155, v155
  v_pk_add_f32 v[160:161], v[160:161], v[88:89] op_sel_hi:[1,0] neg_lo:[0,1] neg_hi:[0,1]
  v_pk_add_f32 v[162:163], v[162:163], v[88:89] op_sel_hi:[1,0] neg_lo:[0,1] neg_hi:[0,1]
  v_exp_f32 v160, v160
  v_exp_f32 v161, v161
  v_exp_f32 v162, v162
  v_exp_f32 v163, v163
  s_nop 0
  v_cvt_pk_bf16_f32 v152, v152, v153
  v_cvt_pk_bf16_f32 v153, v154, v155
  v_cvt_pk_bf16_f32 v154, v160, v161
  v_cvt_pk_bf16_f32 v155, v162, v163
  v_pk_add_f32 v[156:157], v[156:157], v[90:91] op_sel_hi:[1,0] neg_lo:[0,1] neg_hi:[0,1]
  v_pk_add_f32 v[158:159], v[158:159], v[90:91] op_sel_hi:[1,0] neg_lo:[0,1] neg_hi:[0,1]
  v_exp_f32 v156, v156
  v_exp_f32 v157, v157
  v_exp_f32 v158, v158
  v_exp_f32 v159, v159
  v_pk_add_f32 v[164:165], v[164:165], v[90:91] op_sel_hi:[1,0] neg_lo:[0,1] neg_hi:[0,1]
  v_pk_add_f32 v[166:167], v[166:167], v[90:91] op_sel_hi:[1,0] neg_lo:[0,1] neg_hi:[0,1]
  v_exp_f32 v164, v164
  v_exp_f32 v165, v165
  v_exp_f32 v166, v166
  v_exp_f32 v167, v167
  s_nop 0
  v_cvt_pk_bf16_f32 v156, v156, v157
  v_cvt_pk_bf16_f32 v157, v158, v159
  v_cvt_pk_bf16_f32 v158, v164, v165
  v_cvt_pk_bf16_f32 v159, v166, v167
  s_waitcnt lgkmcnt(4)
  v_mfma_f32_16x16x32_bf16 v[72:75], v[64:67], v[152:155], v[72:75]
  v_mfma_f32_16x16x32_bf16 v[76:79], v[68:71], v[152:155], v[76:79]
  v_mfma_f32_16x16x32_bf16 v[80:83], v[64:67], v[156:159], v[80:83]
  v_mfma_f32_16x16x32_bf16 v[84:87], v[68:71], v[156:159], v[84:87]
  ds_read_b64_tr_b16 v[64:65], v22 offset:2560
  ds_read_b64_tr_b16 v[66:67], v22 offset:2816
  ds_read_b64_tr_b16 v[68:69], v23 offset:2560
  ds_read_b64_tr_b16 v[70:71], v23 offset:2816
  v_pk_add_f32 v[168:169], v[168:169], v[88:89] op_sel_hi:[1,0] neg_lo:[0,1] neg_hi:[0,1]
  v_pk_add_f32 v[170:171], v[170:171], v[88:89] op_sel_hi:[1,0] neg_lo:[0,1] neg_hi:[0,1]
  v_exp_f32 v168, v168
  v_exp_f32 v169, v169
  v_exp_f32 v170, v170
  v_exp_f32 v171, v171
  v_pk_add_f32 v[176:177], v[176:177], v[88:89] op_sel_hi:[1,0] neg_lo:[0,1] neg_hi:[0,1]
  v_pk_add_f32 v[178:179], v[178:179], v[88:89] op_sel_hi:[1,0] neg_lo:[0,1] neg_hi:[0,1]
  v_exp_f32 v176, v176
  v_exp_f32 v177, v177
  v_exp_f32 v178, v178
  v_exp_f32 v179, v179
  s_nop 0
  v_cvt_pk_bf16_f32 v168, v168, v169
  v_cvt_pk_bf16_f32 v169, v170, v171
  v_cvt_pk_bf16_f32 v170, v176, v177
  v_cvt_pk_bf16_f32 v171, v178, v179
  v_pk_add_f32 v[172:173], v[172:173], v[90:91] op_sel_hi:[1,0] neg_lo:[0,1] neg_hi:[0,1]
  v_pk_add_f32 v[174:175], v[174:175], v[90:91] op_sel_hi:[1,0] neg_lo:[0,1] neg_hi:[0,1]
  v_exp_f32 v172, v172
  v_exp_f32 v173, v173
  v_exp_f32 v174, v174
  v_exp_f32 v175, v175
  v_pk_add_f32 v[180:181], v[180:181], v[90:91] op_sel_hi:[1,0] neg_lo:[0,1] neg_hi:[0,1]
  v_pk_add_f32 v[182:183], v[182:183], v[90:91] op_sel_hi:[1,0] neg_lo:[0,1] neg_hi:[0,1]
  v_exp_f32 v180, v180
  v_exp_f32 v181, v181
  v_exp_f32 v182, v182
  v_exp_f32 v183, v183
  s_nop 0
  v_cvt_pk_bf16_f32 v172, v172, v173
  v_cvt_pk_bf16_f32 v173, v174, v175
  v_cvt_pk_bf16_f32 v174, v180, v181
  v_cvt_pk_bf16_f32 v175, v182, v183
  s_waitcnt lgkmcnt(4)
  v_mfma_f32_16x16x32_bf16 v[72:75], v[56:59], v[168:171], v[72:75]
  v_mfma_f32_16x16x32_bf16 v[76:79], v[60:63], v[168:171], v[76:79]
  v_mfma_f32_16x16x32_bf16 v[80:83], v[56:59], v[172:175], v[80:83]
  v_mfma_f32_16x16x32_bf16 v[84:87], v[60:63], v[172:175], v[84:87]
  ds_read_b64_tr_b16 v[56:57], v22 offset:3072
  ds_read_b64_tr_b16 v[58:59], v22 offset:3328
  ds_read_b64_tr_b16 v[60:61], v23 offset:3072
  ds_read_b64_tr_b16 v[62:63], v23 offset:3328
  v_pk_add_f32 v[184:185], v[184:185], v[88:89] op_sel_hi:[1,0] neg_lo:[0,1] neg_hi:[0,1]
  v_pk_add_f32 v[186:187], v[186:187], v[88:89] op_sel_hi:[1,0] neg_lo:[0,1] neg_hi:[0,1]
  v_exp_f32 v184, v184
  v_exp_f32 v185, v185
  v_exp_f32 v186, v186
  v_exp_f32 v187, v187
  v_pk_add_f32 v[192:193], v[192:193], v[88:89] op_sel_hi:[1,0] neg_lo:[0,1] neg_hi:[0,1]
  v_pk_add_f32 v[194:195], v[194:195], v[88:89] op_sel_hi:[1,0] neg_lo:[0,1] neg_hi:[0,1]
  v_exp_f32 v192, v192
  v_exp_f32 v193, v193
  v_exp_f32 v194, v194
  v_exp_f32 v195, v195
  s_nop 0
  v_cvt_pk_bf16_f32 v184, v184, v185
  v_cvt_pk_bf16_f32 v185, v186, v187
  v_cvt_pk_bf16_f32 v186, v192, v193
  v_cvt_pk_bf16_f32 v187, v194, v195
  v_pk_add_f32 v[188:189], v[188:189], v[90:91] op_sel_hi:[1,0] neg_lo:[0,1] neg_hi:[0,1]
  v_pk_add_f32 v[190:191], v[190:191], v[90:91] op_sel_hi:[1,0] neg_lo:[0,1] neg_hi:[0,1]
  v_exp_f32 v188, v188
  v_exp_f32 v189, v189
  v_exp_f32 v190, v190
  v_exp_f32 v191, v191
  v_pk_add_f32 v[196:197], v[196:197], v[90:91] op_sel_hi:[1,0] neg_lo:[0,1] neg_hi:[0,1]
  v_pk_add_f32 v[198:199], v[198:199], v[90:91] op_sel_hi:[1,0] neg_lo:[0,1] neg_hi:[0,1]
  v_exp_f32 v196, v196
  v_exp_f32 v197, v197
  v_exp_f32 v198, v198
  v_exp_f32 v199, v199
  s_nop 0
  v_cvt_pk_bf16_f32 v188, v188, v189
  v_cvt_pk_bf16_f32 v189, v190, v191
  v_cvt_pk_bf16_f32 v190, v196, v197
  v_cvt_pk_bf16_f32 v191, v198, v199
  s_waitcnt lgkmcnt(4)
  v_mfma_f32_16x16x32_bf16 v[72:75], v[64:67], v[184:187], v[72:75]
  v_mfma_f32_16x16x32_bf16 v[76:79], v[68:71], v[184:187], v[76:79]
  v_mfma_f32_16x16x32_bf16 v[80:83], v[64:67], v[188:191], v[80:83]
  v_mfma_f32_16x16x32_bf16 v[84:87], v[68:71], v[188:191], v[84:87]
  ds_read_b64_tr_b16 v[64:65], v22 offset:3584
  ds_read_b64_tr_b16 v[66:67], v22 offset:3840
  ds_read_b64_tr_b16 v[68:69], v23 offset:3584
  ds_read_b64_tr_b16 v[70:71], v23 offset:3840
  v_pk_add_f32 v[200:201], v[200:201], v[88:89] op_sel_hi:[1,0] neg_lo:[0,1] neg_hi:[0,1]
  v_pk_add_f32 v[202:203], v[202:203], v[88:89] op_sel_hi:[1,0] neg_lo:[0,1] neg_hi:[0,1]
  v_exp_f32 v200, v200
  v_exp_f32 v201, v201
  v_exp_f32 v202, v202
  v_exp_f32 v203, v203
  v_pk_add_f32 v[208:209], v[208:209], v[88:89] op_sel_hi:[1,0] neg_lo:[0,1] neg_hi:[0,1]
  v_pk_add_f32 v[210:211], v[210:211], v[88:89] op_sel_hi:[1,0] neg_lo:[0,1] neg_hi:[0,1]
  v_exp_f32 v208, v208
  v_exp_f32 v209, v209
  v_exp_f32 v210, v210
  v_exp_f32 v211, v211
  s_nop 0
  v_cvt_pk_bf16_f32 v200, v200, v201
  v_cvt_pk_bf16_f32 v201, v202, v203
  v_cvt_pk_bf16_f32 v202, v208, v209
  v_cvt_pk_bf16_f32 v203, v210, v211
  v_pk_add_f32 v[204:205], v[204:205], v[90:91] op_sel_hi:[1,0] neg_lo:[0,1] neg_hi:[0,1]
  v_pk_add_f32 v[206:207], v[206:207], v[90:91] op_sel_hi:[1,0] neg_lo:[0,1] neg_hi:[0,1]
  v_exp_f32 v204, v204
  v_exp_f32 v205, v205
  v_exp_f32 v206, v206
  v_exp_f32 v207, v207
  v_pk_add_f32 v[212:213], v[212:213], v[90:91] op_sel_hi:[1,0] neg_lo:[0,1] neg_hi:[0,1]
  v_pk_add_f32 v[214:215], v[214:215], v[90:91] op_sel_hi:[1,0] neg_lo:[0,1] neg_hi:[0,1]
  v_exp_f32 v212, v212
  v_exp_f32 v213, v213
  v_exp_f32 v214, v214
  v_exp_f32 v215, v215
  s_nop 0
  v_cvt_pk_bf16_f32 v204, v204, v205
  v_cvt_pk_bf16_f32 v205, v206, v207
  v_cvt_pk_bf16_f32 v206, v212, v213
  v_cvt_pk_bf16_f32 v207, v214, v215
  s_waitcnt lgkmcnt(4)
  v_mfma_f32_16x16x32_bf16 v[72:75], v[56:59], v[200:203], v[72:75]
  v_mfma_f32_16x16x32_bf16 v[76:79], v[60:63], v[200:203], v[76:79]
  v_mfma_f32_16x16x32_bf16 v[80:83], v[56:59], v[204:207], v[80:83]
  v_mfma_f32_16x16x32_bf16 v[84:87], v[60:63], v[204:207], v[84:87]
  ds_read_b64_tr_b16 v[56:57], v22 offset:4096
  ds_read_b64_tr_b16 v[58:59], v22 offset:4352
  ds_read_b64_tr_b16 v[60:61], v23 offset:4096
  ds_read_b64_tr_b16 v[62:63], v23 offset:4352
  v_pk_add_f32 v[216:217], v[216:217], v[88:89] op_sel_hi:[1,0] neg_lo:[0,1] neg_hi:[0,1]
  v_pk_add_f32 v[218:219], v[218:219], v[88:89] op_sel_hi:[1,0] neg_lo:[0,1] neg_hi:[0,1]
  v_exp_f32 v216, v216
  v_exp_f32 v217, v217
  v_exp_f32 v218, v218
  v_exp_f32 v219, v219
  v_pk_add_f32 v[224:225], v[224:225], v[88:89] op_sel_hi:[1,0] neg_lo:[0,1] neg_hi:[0,1]
  v_pk_add_f32 v[226:227], v[226:227], v[88:89] op_sel_hi:[1,0] neg_lo:[0,1] neg_hi:[0,1]
  v_exp_f32 v224, v224
  v_exp_f32 v225, v225
  v_exp_f32 v226, v226
  v_exp_f32 v227, v227
  s_nop 0
  v_cvt_pk_bf16_f32 v216, v216, v217
  v_cvt_pk_bf16_f32 v217, v218, v219
  v_cvt_pk_bf16_f32 v218, v224, v225
  v_cvt_pk_bf16_f32 v219, v226, v227
  v_pk_add_f32 v[220:221], v[220:221], v[90:91] op_sel_hi:[1,0] neg_lo:[0,1] neg_hi:[0,1]
  v_pk_add_f32 v[222:223], v[222:223], v[90:91] op_sel_hi:[1,0] neg_lo:[0,1] neg_hi:[0,1]
  v_exp_f32 v220, v220
  v_exp_f32 v221, v221
  v_exp_f32 v222, v222
  v_exp_f32 v223, v223
  v_pk_add_f32 v[228:229], v[228:229], v[90:91] op_sel_hi:[1,0] neg_lo:[0,1] neg_hi:[0,1]
  v_pk_add_f32 v[230:231], v[230:231], v[90:91] op_sel_hi:[1,0] neg_lo:[0,1] neg_hi:[0,1]
  v_exp_f32 v228, v228
  v_exp_f32 v229, v229
  v_exp_f32 v230, v230
  v_exp_f32 v231, v231
  s_nop 0
  v_cvt_pk_bf16_f32 v220, v220, v221
  v_cvt_pk_bf16_f32 v221, v222, v223
  v_cvt_pk_bf16_f32 v222, v228, v229
  v_cvt_pk_bf16_f32 v223, v230, v231
  s_waitcnt lgkmcnt(4)
  v_mfma_f32_16x16x32_bf16 v[72:75], v[64:67], v[216:219], v[72:75]
  v_mfma_f32_16x16x32_bf16 v[76:79], v[68:71], v[216:219], v[76:79]
  v_mfma_f32_16x16x32_bf16 v[80:83], v[64:67], v[220:223], v[80:83]
  v_mfma_f32_16x16x32_bf16 v[84:87], v[68:71], v[220:223], v[84:87]
  v_pk_add_f32 v[232:233], v[232:233], v[88:89] op_sel_hi:[1,0] neg_lo:[0,1] neg_hi:[0,1]
  v_pk_add_f32 v[234:235], v[234:235], v[88:89] op_sel_hi:[1,0] neg_lo:[0,1] neg_hi:[0,1]
  v_exp_f32 v232, v232
  v_exp_f32 v233, v233
  v_exp_f32 v234, v234
  v_exp_f32 v235, v235
  s_nop 0
  v_cvt_pk_bf16_f32 v232, v232, v233
  v_cvt_pk_bf16_f32 v233, v234, v235
  v_mov_b32 v234, 0
  v_mov_b32 v235, 0
  v_pk_add_f32 v[236:237], v[236:237], v[90:91] op_sel_hi:[1,0] neg_lo:[0,1] neg_hi:[0,1]
  v_pk_add_f32 v[238:239], v[238:239], v[90:91] op_sel_hi:[1,0] neg_lo:[0,1] neg_hi:[0,1]
  v_exp_f32 v236, v236
  v_exp_f32 v237, v237
  v_exp_f32 v238, v238
  v_exp_f32 v239, v239
  v_pk_add_f32 v[244:245], v[244:245], v[90:91] op_sel_hi:[1,0] neg_lo:[0,1] neg_hi:[0,1]
  v_pk_add_f32 v[246:247], v[246:247], v[90:91] op_sel_hi:[1,0] neg_lo:[0,1] neg_hi:[0,1]
  v_exp_f32 v244, v244
  v_exp_f32 v245, v245
  v_exp_f32 v246, v246
  v_exp_f32 v247, v247
  s_nop 0
  v_cvt_pk_bf16_f32 v236, v236, v237
  v_cvt_pk_bf16_f32 v237, v238, v239
  v_cvt_pk_bf16_f32 v238, v244, v245
  v_cvt_pk_bf16_f32 v239, v246, v247
  s_waitcnt lgkmcnt(0)
  v_mfma_f32_16x16x32_bf16 v[72:75], v[56:59], v[232:235], v[72:75]
  v_mfma_f32_16x16x32_bf16 v[76:79], v[60:63], v[232:235], v[76:79]
  v_mfma_f32_16x16x32_bf16 v[80:83], v[56:59], v[236:239], v[80:83]
  v_mfma_f32_16x16x32_bf16 v[84:87], v[60:63], v[236:239], v[84:87]
  s_nop 7
  v_mov_b32 v4, v76
  v_mov_b32 v5, v76
  s_nop 1
  v_permlane16_swap_b32 v4, v5
  s_nop 0
  v_rcp_f32 v5, v5
  s_nop 0
  v_mul_f32 v72, v72, v5
  v_mul_f32 v73, v73, v5
  v_mul_f32 v74, v74, v5
  v_mul_f32 v75, v75, v5
  v_mul_f32 v76, v76, v5
  v_mul_f32 v77, v77, v5
  v_mul_f32 v78, v78, v5
  v_mul_f32 v79, v79, v5
  v_cvt_pk_bf16_f32 v72, v72, v73
  v_cvt_pk_bf16_f32 v73, v74, v75
  v_cvt_pk_bf16_f32 v76, v76, v77
  v_cvt_pk_bf16_f32 v77, v78, v79
  ds_write_b64 v24, v[72:73] offset:0
  ds_write_b64 v25, v[76:77] offset:0
  v_mov_b32 v4, v84
  v_mov_b32 v5, v84
  s_nop 1
  v_permlane16_swap_b32 v4, v5
  s_nop 0
  v_rcp_f32 v5, v5
  s_nop 0
  v_mul_f32 v80, v80, v5
  v_mul_f32 v81, v81, v5
  v_mul_f32 v82, v82, v5
  v_mul_f32 v83, v83, v5
  v_mul_f32 v84, v84, v5
  v_mul_f32 v85, v85, v5
  v_mul_f32 v86, v86, v5
  v_mul_f32 v87, v87, v5
  v_cvt_pk_bf16_f32 v80, v80, v81
  v_cvt_pk_bf16_f32 v81, v82, v83
  v_cvt_pk_bf16_f32 v84, v84, v85
  v_cvt_pk_bf16_f32 v85, v86, v87
  ds_write_b64 v24, v[80:81] offset:256
  ds_write_b64 v25, v[84:85] offset:256
  s_lshl_b32 s39, s20, 11
  s_add_u32 s39, s39, 81920
  v_lshl_add_u32 v4, v1, 4, s39
  s_mul_i32 s39, s22, 5
  s_add_u32 s39, s39, s20
  s_mul_i32 s39, s39, 32768
  s_lshl_b32 s40, s21, 11
  s_add_u32 s39, s39, s40
  v_lshlrev_b32 v5, 4, v1
  s_waitcnt lgkmcnt(0)
  s_barrier
  s_cmp_ge_u32 s20, 5
  s_cbranch_scc1 L_nost_60
  ds_read_b128 v[72:75], v4
  ds_read_b128 v[76:79], v4 offset:1024
  s_waitcnt lgkmcnt(1)
  buffer_store_dwordx4 v[72:75], v5, s[12:15], s39 offen sc1
  s_waitcnt lgkmcnt(0)
  buffer_store_dwordx4 v[76:79], v5, s[12:15], s39 offen offset:1024 sc1
L_nost_60:
  s_waitcnt vmcnt(0)
  s_barrier
  s_cmp_lg_u32 s20, 0
  s_cbranch_scc1 L_sig_61
  s_add_u32 s16, s60, 0x1a00000
  s_addc_u32 s17, s61, 0
  s_and_b32 s17, s17, 0xffff
  s_mov_b32 s18, 0x2000
  s_mov_b32 s19, 0x20000
  s_lshl_b32 s39, s21, 7
  s_lshl_b32 s40, s22, 3
  s_add_u32 s39, s39, s40
  v_mov_b32 v4, 2048
  v_mov_b32 v12, s90
  v_mov_b32 v13, s91
  s_mov_b64 exec, 1
  buffer_store_dwordx2 v[12:13], v4, s[16:19], s39 offen sc1
  s_mov_b64 exec, -1
L_sig_61:
  s_lshl_b32 s28, s21, 7
  s_and_b32 s39, s22, 1
  s_lshl_b32 s39, s39, 6
  s_add_u32 s28, s28, s39
  s_lshr_b32 s38, s22, 1
  s_mul_i32 s29, s38, 80
  s_mov_b32 s77, -110592
  s_mov_b32 s36, 0
  s_mov_b32 s30, 0
  s_cmp_ge_u32 s20, 4
  s_cbranch_scc1 L_p3_ld_62
  s_lshr_b32 s74, s23, 1
  s_and_b32 s75, s23, 1
  v_mul_u32_u24 v28, 1024, v2
  v_lshl_add_u32 v28, v3, 4, v28
  s_mul_i32 s39, s74, 512
  v_add_u32 v28, s39, v28
  s_mul_i32 s39, s75, 4096
  v_add_u32 v28, s39, v28
  s_lshl_b32 s39, s75, 8
  v_sub_u32 v29, v28, s39
  v_add_u32 v29, 256, v29
  v_add_u32 v28, s39, v28
  v_lshrrev_b32 v4, 2, v3
  v_and_b32 v5, 3, v3
  v_lshl_add_u32 v4, v2, 2, v4
  v_mul_u32_u24 v4, 160, v4
  v_lshl_add_u32 v30, v5, 3, v4
  v_add_u32 v30, 8192, v30
  s_mul_i32 s39, s75, 5120
  v_add_u32 v30, s39, v30
  v_mov_b32 v32, 0
  v_mov_b32 v33, 0
  v_mov_b32 v34, 0
  v_mov_b32 v35, 0
  v_mov_b32 v36, 0
  v_mov_b32 v37, 0
  v_mov_b32 v38, 0
  v_mov_b32 v39, 0
  v_mov_b32 v40, 0
  v_mov_b32 v41, 0
  v_mov_b32 v42, 0
  v_mov_b32 v43, 0
  v_mov_b32 v44, 0
  v_mov_b32 v45, 0
  v_mov_b32 v46, 0
  v_mov_b32 v47, 0
  v_mov_b32 v48, 0
  v_mov_b32 v49, 0
  v_mov_b32 v50, 0
  v_mov_b32 v51, 0
  v_mov_b32 v52, 0
  v_mov_b32 v53, 0
  v_mov_b32 v54, 0
  v_mov_b32 v55, 0
  v_mov_b32 v56, 0
  v_mov_b32 v57, 0
  v_mov_b32 v58, 0
  v_mov_b32 v59, 0
  v_mov_b32 v60, 0
  v_mov_b32 v61, 0
  v_mov_b32 v62, 0
  v_mov_b32 v63, 0
  v_mov_b32 v64, 0
  v_mov_b32 v65, 0
  v_mov_b32 v66, 0
  v_mov_b32 v67, 0
  v_mov_b32 v68, 0
  v_mov_b32 v69, 0
  v_mov_b32 v70, 0
  v_mov_b32 v71, 0
  s_add_u32 s12, s60, 0xb00000
  s_addc_u32 s13, s61, 0
  s_and_b32 s13, s13, 0xffff
  s_mov_b32 s14, 0x280000
  s_mov_b32 s15, 0x20000
  s_mov_b32 s16, s44
  s_and_b32 s17, s45, 0xffff
  s_mov_b32 s18, 0x280000
  s_mov_b32 s19, 0x20000
  s_lshl_b32 s39, s23, 4
  s_add_u32 s39, s39, s28
  v_add_u32 v4, s39, v3
  v_mul_u32_u24 v4, 1280, v4
  v_lshl_add_u32 v4, v2, 3, v4
  s_lshl_b32 s39, s29, 1
  v_add_u32 v4, s39, v4
  buffer_load_dwordx2 v[128:129], v4, s[16:19], 0 offen offset:0
  buffer_load_dwordx2 v[130:131], v4, s[16:19], 0 offen offset:32
  buffer_load_dwordx2 v[132:133], v4, s[16:19], 0 offen offset:64
  buffer_load_dwordx2 v[134:135], v4, s[16:19], 0 offen offset:96
  buffer_load_dwordx2 v[136:137], v4, s[16:19], 0 offen offset:128
  s_barrier
  ds_read_b64_tr_b16 v[88:89], v30 offset:0
  ds_read_b64_tr_b16 v[90:91], v30 offset:2560
  ds_read_b64_tr_b16 v[92:93], v30 offset:32
  ds_read_b64_tr_b16 v[94:95], v30 offset:2592
  ds_read_b64_tr_b16 v[96:97], v30 offset:64
  ds_read_b64_tr_b16 v[98:99], v30 offset:2624
  ds_read_b64_tr_b16 v[100:101], v30 offset:96
  ds_read_b64_tr_b16 v[102:103], v30 offset:2656
  ds_read_b64_tr_b16 v[104:105], v30 offset:128
  ds_read_b64_tr_b16 v[106:107], v30 offset:2688
  ds_read_b128 v[72:75], v28 offset:0
  ds_read_b128 v[76:79], v29 offset:0
L_p3_loop_64:
  s_barrier
  s_add_u32 s36, s36, 1
  s_cmp_eq_u32 s36, 7
  s_cselect_b32 s35, s77, 18432
  s_cselect_b32 s36, 0, s36
  v_add_u32 v28, s35, v28
  v_add_u32 v29, s35, v29
  v_add_u32 v30, s35, v30
  s_waitcnt lgkmcnt(0)
  ds_read_b64_tr_b16 v[108:109], v30 offset:0
  ds_read_b64_tr_b16 v[110:111], v30 offset:2560
  v_mfma_f32_16x16x32_bf16 v[32:35], v[88:91], v[72:75], v[32:35]
  ds_read_b64_tr_b16 v[112:113], v30 offset:32
  ds_read_b64_tr_b16 v[114:115], v30 offset:2592
  v_mfma_f32_16x16x32_bf16 v[36:39], v[92:95], v[72:75], v[36:39]
  ds_read_b64_tr_b16 v[116:117], v30 offset:64
  ds_read_b64_tr_b16 v[118:119], v30 offset:2624
  v_mfma_f32_16x16x32_bf16 v[40:43], v[96:99], v[72:75], v[40:43]
  ds_read_b64_tr_b16 v[120:121], v30 offset:96
  ds_read_b64_tr_b16 v[122:123], v30 offset:2656
  v_mfma_f32_16x16x32_bf16 v[44:47], v[100:103], v[72:75], v[44:47]
  ds_read_b64_tr_b16 v[124:125], v30 offset:128
  ds_read_b64_tr_b16 v[126:127], v30 offset:2688
  v_mfma_f32_16x16x32_bf16 v[48:51], v[104:107], v[72:75], v[48:51]
  ds_read_b128 v[80:83], v28 offset:0
  ds_read_b128 v[84:87], v29 offset:0
  v_mfma_f32_16x16x32_bf16 v[52:55], v[88:91], v[76:79], v[52:55]
  v_mfma_f32_16x16x32_bf16 v[56:59], v[92:95], v[76:79], v[56:59]
  v_mfma_f32_16x16x32_bf16 v[60:63], v[96:99], v[76:79], v[60:63]
  v_mfma_f32_16x16x32_bf16 v[64:67], v[100:103], v[76:79], v[64:67]
  v_mfma_f32_16x16x32_bf16 v[68:71], v[104:107], v[76:79], v[68:71]
  s_barrier
  s_add_u32 s36, s36, 1
  s_cmp_eq_u32 s36, 7
  s_cselect_b32 s35, s77, 18432
  s_cselect_b32 s36, 0, s36
  v_add_u32 v28, s35, v28
  v_add_u32 v29, s35, v29
  v_add_u32 v30, s35, v30
  s_waitcnt lgkmcnt(0)
  ds_read_b64_tr_b16 v[88:89], v30 offset:0
  ds_read_b64_tr_b16 v[90:91], v30 offset:2560
  v_mfma_f32_16x16x32_bf16 v[32:35], v[108:111], v[80:83], v[32:35]
  ds_read_b64_tr_b16 v[92:93], v30 offset:32
  ds_read_b64_tr_b16 v[94:95], v30 offset:2592
  v_mfma_f32_16x16x32_bf16 v[36:39], v[112:115], v[80:83], v[36:39]
  ds_read_b64_tr_b16 v[96:97], v30 offset:64
  ds_read_b64_tr_b16 v[98:99], v30 offset:2624
  v_mfma_f32_16x16x32_bf16 v[40:43], v[116:119], v[80:83], v[40:43]
  ds_read_b64_tr_b16 v[100:101], v30 offset:96
  ds_read_b64_tr_b16 v[102:103], v30 offset:2656
  v_mfma_f32_16x16x32_bf16 v[44:47], v[120:123], v[80:83], v[44:47]
  ds_read_b64_tr_b16 v[104:105], v30 offset:128
  ds_read_b64_tr_b16 v[106:107], v30 offset:2688
  v_mfma_f32_16x16x32_bf16 v[48:51], v[124:127], v[80:83], v[48:51]
  ds_read_b128 v[72:75], v28 offset:0
  ds_read_b128 v[76:79], v29 offset:0
  v_mfma_f32_16x16x32_bf16 v[52:55], v[108:111], v[84:87], v[52:55]
  v_mfma_f32_16x16x32_bf16 v[56:59], v[112:115], v[84:87], v[56:59]
  v_mfma_f32_16x16x32_bf16 v[60:63], v[116:119], v[84:87], v[60:63]
  v_mfma_f32_16x16x32_bf16 v[64:67], v[120:123], v[84:87], v[64:67]
  v_mfma_f32_16x16x32_bf16 v[68:71], v[124:127], v[84:87], v[68:71]
  s_add_u32 s30, s30, 1
  s_cmp_lt_u32 s30, 4
  s_cbranch_scc1 L_p3_loop_64
  s_barrier
  s_add_u32 s36, s36, 1
  s_cmp_eq_u32 s36, 7
  s_cselect_b32 s35, s77, 18432
  s_cselect_b32 s36, 0, s36
  v_add_u32 v28, s35, v28
  v_add_u32 v29, s35, v29
  v_add_u32 v30, s35, v30
  s_waitcnt lgkmcnt(0)
  ds_read_b64_tr_b16 v[108:109], v30 offset:0
  ds_read_b64_tr_b16 v[110:111], v30 offset:2560
  v_mfma_f32_16x16x32_bf16 v[32:35], v[88:91], v[72:75], v[32:35]
  ds_read_b64_tr_b16 v[112:113], v30 offset:32
  ds_read_b64_tr_b16 v[114:115], v30 offset:2592
  v_mfma_f32_16x16x32_bf16 v[36:39], v[92:95], v[72:75], v[36:39]
  ds_read_b64_tr_b16 v[116:117], v30 offset:64
  ds_read_b64_tr_b16 v[118:119], v30 offset:2624
  v_mfma_f32_16x16x32_bf16 v[40:43], v[96:99], v[72:75], v[40:43]
  ds_read_b64_tr_b16 v[120:121], v30 offset:96
  ds_read_b64_tr_b16 v[122:123], v30 offset:2656
  v_mfma_f32_16x16x32_bf16 v[44:47], v[100:103], v[72:75], v[44:47]
  ds_read_b64_tr_b16 v[124:125], v30 offset:128
  ds_read_b64_tr_b16 v[126:127], v30 offset:2688
  v_mfma_f32_16x16x32_bf16 v[48:51], v[104:107], v[72:75], v[48:51]
  ds_read_b128 v[80:83], v28 offset:0
  ds_read_b128 v[84:87], v29 offset:0
  v_mfma_f32_16x16x32_bf16 v[52:55], v[88:91], v[76:79], v[52:55]
  v_mfma_f32_16x16x32_bf16 v[56:59], v[92:95], v[76:79], v[56:59]
  v_mfma_f32_16x16x32_bf16 v[60:63], v[96:99], v[76:79], v[60:63]
  v_mfma_f32_16x16x32_bf16 v[64:67], v[100:103], v[76:79], v[64:67]
  v_mfma_f32_16x16x32_bf16 v[68:71], v[104:107], v[76:79], v[68:71]
  s_waitcnt lgkmcnt(0)
  v_mfma_f32_16x16x32_bf16 v[32:35], v[108:111], v[80:83], v[32:35]
  v_mfma_f32_16x16x32_bf16 v[36:39], v[112:115], v[80:83], v[36:39]
  v_mfma_f32_16x16x32_bf16 v[40:43], v[116:119], v[80:83], v[40:43]
  v_mfma_f32_16x16x32_bf16 v[44:47], v[120:123], v[80:83], v[44:47]
  v_mfma_f32_16x16x32_bf16 v[48:51], v[124:127], v[80:83], v[48:51]
  v_mfma_f32_16x16x32_bf16 v[52:55], v[108:111], v[84:87], v[52:55]
  v_mfma_f32_16x16x32_bf16 v[56:59], v[112:115], v[84:87], v[56:59]
  v_mfma_f32_16x16x32_bf16 v[60:63], v[116:119], v[84:87], v[60:63]
  v_mfma_f32_16x16x32_bf16 v[64:67], v[120:123], v[84:87], v[64:67]
  v_mfma_f32_16x16x32_bf16 v[68:71], v[124:127], v[84:87], v[68:71]
  s_nop 7
  s_mul_i32 s39, s23, 5120
  s_add_u32 s39, s39, 131072
  v_lshl_add_u32 v4, v1, 4, s39
  ds_write_b128 v4, v[52:55] offset:0
  ds_write_b128 v4, v[56:59] offset:1024
  ds_write_b128 v4, v[60:63] offset:2048
  ds_write_b128 v4, v[64:67] offset:3072
  ds_write_b128 v4, v[68:71] offset:4096
  s_xor_b32 s39, s23, 1
  s_mul_i32 s39, s39, 5120
  s_add_u32 s39, s39, 131072
  v_lshl_add_u32 v4, v1, 4, s39
  s_waitcnt lgkmcnt(0)
  s_barrier
  ds_read_b128 v[52:55], v4 offset:0
  ds_read_b128 v[56:59], v4 offset:1024
  ds_read_b128 v[60:63], v4 offset:2048
  ds_read_b128 v[64:67], v4 offset:3072
  ds_read_b128 v[68:71], v4 offset:4096
  s_lshl_b32 s39, s23, 4
  s_add_u32 s39, s39, s28
  v_add_u32 v4, s39, v3
  v_and_b32 v5, 1, v2
  v_lshlrev_b32 v5, 1, v5
  v_lshrrev_b32 v6, 1, v2
  v_add_u32 v5, v5, v6
  v_mul_u32_u24 v5, 32768, v5
  v_lshl_add_u32 v138, v4, 4, v5
  v_mul_u32_u24 v6, 32768, v6
  v_lshl_add_u32 v6, v4, 4, v6
  v_and_b32 v5, 1, v2
  v_lshl_add_u32 v6, v5, 3, v6
  s_lshr_b32 s39, s29, 3
  s_mul_i32 s70, s39, 32768
  s_add_u32 s71, s70, 131072
  s_add_u32 s72, s70, 262144
  s_waitcnt vmcnt(0) lgkmcnt(0)
  v_pk_add_f32 v[32:33], v[32:33], v[52:53]
  v_pk_add_f32 v[34:35], v[34:35], v[54:55]
  v_lshlrev_b32 v4, 16, v128
  v_and_b32 v5, 0xffff0000, v128
  v_add_f32 v32, v32, v4
  v_add_f32 v33, v33, v5
  v_lshlrev_b32 v4, 16, v129
  v_and_b32 v5, 0xffff0000, v129
  v_add_f32 v34, v34, v4
  v_add_f32 v35, v35, v5
  v_cvt_pk_bf16_f32 v140, v32, v33
  v_cvt_pk_bf16_f32 v141, v34, v35
  v_add_f32 v72, v32, v33
  v_mul_f32 v73, v32, v32
  v_fmac_f32 v73, v33, v33
  v_add_f32 v72, v72, v34
  v_fmac_f32 v73, v34, v34
  v_add_f32 v72, v72, v35
  v_fmac_f32 v73, v35, v35
  v_pk_add_f32 v[36:37], v[36:37], v[56:57]
  v_pk_add_f32 v[38:39], v[38:39], v[58:59]
  v_lshlrev_b32 v4, 16, v130
  v_and_b32 v5, 0xffff0000, v130
  v_add_f32 v36, v36, v4
  v_add_f32 v37, v37, v5
  v_lshlrev_b32 v4, 16, v131
  v_and_b32 v5, 0xffff0000, v131
  v_add_f32 v38, v38, v4
  v_add_f32 v39, v39, v5
  v_cvt_pk_bf16_f32 v142, v36, v37
  v_cvt_pk_bf16_f32 v143, v38, v39
  v_add_f32 v72, v72, v36
  v_fmac_f32 v73, v36, v36
  v_add_f32 v72, v72, v37
  v_fmac_f32 v73, v37, v37
  v_add_f32 v72, v72, v38
  v_fmac_f32 v73, v38, v38
  v_add_f32 v72, v72, v39
  v_fmac_f32 v73, v39, v39
  s_nop 1
  v_permlane16_swap_b32 v140, v142
  v_permlane16_swap_b32 v141, v143
  buffer_store_dwordx4 v[140:143], v138, s[12:15], s70 offen sc1
  v_pk_add_f32 v[40:41], v[40:41], v[60:61]
  v_pk_add_f32 v[42:43], v[42:43], v[62:63]
  v_lshlrev_b32 v4, 16, v132
  v_and_b32 v5, 0xffff0000, v132
  v_add_f32 v40, v40, v4
  v_add_f32 v41, v41, v5
  v_lshlrev_b32 v4, 16, v133
  v_and_b32 v5, 0xffff0000, v133
  v_add_f32 v42, v42, v4
  v_add_f32 v43, v43, v5
  v_cvt_pk_bf16_f32 v144, v40, v41
  v_cvt_pk_bf16_f32 v145, v42, v43
  v_add_f32 v72, v72, v40
  v_fmac_f32 v73, v40, v40
  v_add_f32 v72, v72, v41
  v_fmac_f32 v73, v41, v41
  v_add_f32 v72, v72, v42
  v_fmac_f32 v73, v42, v42
  v_add_f32 v72, v72, v43
  v_fmac_f32 v73, v43, v43
  v_pk_add_f32 v[44:45], v[44:45], v[64:65]
  v_pk_add_f32 v[46:47], v[46:47], v[66:67]
  v_lshlrev_b32 v4, 16, v134
  v_and_b32 v5, 0xffff0000, v134
  v_add_f32 v44, v44, v4
  v_add_f32 v45, v45, v5
  v_lshlrev_b32 v4, 16, v135
  v_and_b32 v5, 0xffff0000, v135
  v_add_f32 v46, v46, v4
  v_add_f32 v47, v47, v5
  v_cvt_pk_bf16_f32 v146, v44, v45
  v_cvt_pk_bf16_f32 v147, v46, v47
  v_add_f32 v72, v72, v44
  v_fmac_f32 v73, v44, v44
  v_add_f32 v72, v72, v45
  v_fmac_f32 v73, v45, v45
  v_add_f32 v72, v72, v46
  v_fmac_f32 v73, v46, v46
  v_add_f32 v72, v72, v47
  v_fmac_f32 v73, v47, v47
  s_nop 1
  v_permlane16_swap_b32 v144, v146
  v_permlane16_swap_b32 v145, v147
  buffer_store_dwordx4 v[144:147], v138, s[12:15], s71 offen sc1
  v_pk_add_f32 v[48:49], v[48:49], v[68:69]
  v_pk_add_f32 v[50:51], v[50:51], v[70:71]
  v_lshlrev_b32 v4, 16, v136
  v_and_b32 v5, 0xffff0000, v136
  v_add_f32 v48, v48, v4
  v_add_f32 v49, v49, v5
  v_lshlrev_b32 v4, 16, v137
  v_and_b32 v5, 0xffff0000, v137
  v_add_f32 v50, v50, v4
  v_add_f32 v51, v51, v5
  v_cvt_pk_bf16_f32 v140, v48, v49
  v_cvt_pk_bf16_f32 v141, v50, v51
  v_add_f32 v72, v72, v48
  v_fmac_f32 v73, v48, v48
  v_add_f32 v72, v72, v49
  v_fmac_f32 v73, v49, v49
  v_add_f32 v72, v72, v50
  v_fmac_f32 v73, v50, v50
  v_add_f32 v72, v72, v51
  v_fmac_f32 v73, v51, v51
  buffer_store_dwordx2 v[140:141], v6, s[12:15], s72 offen sc1
  v_mov_b32 v4, v72
  s_nop 1
  v_permlane32_swap_b32 v72, v4
  s_nop 0
  v_add_f32 v72, v72, v4
  v_mov_b32 v4, v72
  s_nop 1
  v_permlane16_swap_b32 v72, v4
  s_nop 0
  v_add_f32 v72, v72, v4
  v_mov_b32 v4, v73
  s_nop 1
  v_permlane32_swap_b32 v73, v4
  s_nop 0
  v_add_f32 v73, v73, v4
  v_mov_b32 v4, v73
  s_nop 1
  v_permlane16_swap_b32 v73, v4
  s_nop 0
  v_add_f32 v73, v73, v4
  s_add_u32 s16, s60, 0x1a10000
  s_addc_u32 s17, s61, 0
  s_and_b32 s17, s17, 0xffff
  s_mov_b32 s18, 0x20000
  s_mov_b32 s19, 0x20000
  s_lshl_b32 s39, s23, 4
  s_add_u32 s39, s39, s28
  v_add_u32 v4, s39, v3
  v_lshlrev_b32 v4, 6, v4
  s_lshl_b32 s39, s38, 3
  s_mov_b64 exec, 0xffff
  buffer_store_dwordx2 v[72:73], v4, s[16:19], s39 offen sc1
  s_mov_b64 exec, -1
  s_waitcnt vmcnt(0)
  s_barrier
  s_cmp_lg_u32 s20, 0
  s_cbranch_scc1 L_sig_65
  s_add_u32 s16, s60, 0x1a00000
  s_addc_u32 s17, s61, 0
  s_and_b32 s17, s17, 0xffff
  s_mov_b32 s18, 0x2000
  s_mov_b32 s19, 0x20000
  s_lshl_b32 s39, s21, 7
  s_lshl_b32 s40, s22, 3
  s_add_u32 s39, s39, s40
  v_mov_b32 v4, 4096
  v_mov_b32 v12, s90
  v_mov_b32 v13, s91
  s_mov_b64 exec, 1
  buffer_store_dwordx2 v[12:13], v4, s[16:19], s39 offen sc1
  s_mov_b64 exec, -1
L_sig_65:
  s_branch L_p3_join_63
L_p3_ld_62:
  s_and_b32 s75, s23, 1
  s_mov_b32 s33, 0
  s_cmp_ge_u32 s23, 2
  s_cbranch_scc1 L_p3_ldA_66
  s_lshl_b32 s62, s75, 10
  s_add_u32 s62, s62, 8192
  s_lshl_b32 s39, s75, 10
  v_lshl_add_u32 v20, v1, 4, s39
  v_add_u32 v21, 2048, v20
  v_add_u32 v22, 4096, v20
  v_add_u32 v23, 6144, v20
  v_add_u32 v24, 8192, v20
  s_add_u32 s8, s60, 0x1600000
  s_addc_u32 s9, s61, 0
  s_and_b32 s9, s9, 0xffff
  s_mov_b32 s10, 0xc8000
  s_mov_b32 s11, 0x20000
  s_mul_i32 s31, s38, 102400
  s_add_u32 s16, s60, 0x1a00000
  s_addc_u32 s17, s61, 0
  s_and_b32 s17, s17, 0xffff
  s_mov_b32 s18, 0x2000
  s_mov_b32 s19, 0x20000
  v_lshlrev_b32 v4, 7, v1
  v_add_u32 v4, 120, v4
  s_mov_b32 exec_lo, 0xffff
  s_mov_b32 exec_hi, 0x0
  s_mov_b32 s86, 0
L_poll_69:
  buffer_load_dwordx2 v[12:13], v4, s[16:19], 0 offen sc1
  s_waitcnt vmcnt(0)
  v_xor_b32 v12, s90, v12
  v_xor_b32 v13, s91, v13
  v_or_b32 v12, v12, v13
  v_cmp_eq_u32 vcc, 0, v12
  s_add_u32 s86, s86, 1
  s_cmp_eq_u64 vcc, exec
  s_cbranch_scc1 L_pdone_70
  s_sleep 4
  s_cmp_lt_u32 s86, 0x40000
  s_cbranch_scc1 L_poll_69
L_pdone_70:
  s_mov_b64 exec, -1
L_pskip_68:
  s_add_u32 s39, s33, s62
  s_add_u32 m0, s39, 0
  s_nop 0
  buffer_load_dwordx4 v20, s[8:11], s31 offen sc1 lds
  s_add_u32 m0, s39, 2048
  s_nop 0
  buffer_load_dwordx4 v21, s[8:11], s31 offen sc1 lds
  s_add_u32 m0, s39, 4096
  s_nop 0
  buffer_load_dwordx4 v22, s[8:11], s31 offen sc1 lds
  s_add_u32 m0, s39, 6144
  s_nop 0
  buffer_load_dwordx4 v23, s[8:11], s31 offen sc1 lds
  s_add_u32 m0, s39, 8192
  s_nop 0
  buffer_load_dwordx4 v24, s[8:11], s31 offen sc1 lds
  s_add_u32 s31, s31, 10240
  s_add_u32 s36, s36, 1
  s_cmp_eq_u32 s36, 7
  s_cselect_b32 s35, s77, 18432
  s_cselect_b32 s36, 0, s36
  s_add_u32 s33, s33, s35
  s_add_u32 s39, s33, s62
  s_add_u32 m0, s39, 0
  s_nop 0
  buffer_load_dwordx4 v20, s[8:11], s31 offen sc1 lds
  s_add_u32 m0, s39, 2048
  s_nop 0
  buffer_load_dwordx4 v21, s[8:11], s31 offen sc1 lds
  s_add_u32 m0, s39, 4096
  s_nop 0
  buffer_load_dwordx4 v22, s[8:11], s31 offen sc1 lds
  s_add_u32 m0, s39, 6144
  s_nop 0
  buffer_load_dwordx4 v23, s[8:11], s31 offen sc1 lds
  s_add_u32 m0, s39, 8192
  s_nop 0
  buffer_load_dwordx4 v24, s[8:11], s31 offen sc1 lds
  s_add_u32 s31, s31, 10240
  s_add_u32 s36, s36, 1
  s_cmp_eq_u32 s36, 7
  s_cselect_b32 s35, s77, 18432
  s_cselect_b32 s36, 0, s36
  s_add_u32 s33, s33, s35
  s_add_u32 s39, s33, s62
  s_add_u32 m0, s39, 0
  s_nop 0
  buffer_load_dwordx4 v20, s[8:11], s31 offen sc1 lds
  s_add_u32 m0, s39, 2048
  s_nop 0
  buffer_load_dwordx4 v21, s[8:11], s31 offen sc1 lds
  s_add_u32 m0, s39, 4096
  s_nop 0
  buffer_load_dwordx4 v22, s[8:11], s31 offen sc1 lds
  s_add_u32 m0, s39, 6144
  s_nop 0
  buffer_load_dwordx4 v23, s[8:11], s31 offen sc1 lds
  s_add_u32 m0, s39, 8192
  s_nop 0
  buffer_load_dwordx4 v24, s[8:11], s31 offen sc1 lds
  s_add_u32 s31, s31, 10240
  s_add_u32 s36, s36, 1
  s_cmp_eq_u32 s36, 7
  s_cselect_b32 s35, s77, 18432
  s_cselect_b32 s36, 0, s36
  s_add_u32 s33, s33, s35
  s_add_u32 s39, s33, s62
  s_add_u32 m0, s39, 0
  s_nop 0
  buffer_load_dwordx4 v20, s[8:11], s31 offen sc1 lds
  s_add_u32 m0, s39, 2048
  s_nop 0
  buffer_load_dwordx4 v21, s[8:11], s31 offen sc1 lds
  s_add_u32 m0, s39, 4096
  s_nop 0
  buffer_load_dwordx4 v22, s[8:11], s31 offen sc1 lds
  s_add_u32 m0, s39, 6144
  s_nop 0
  buffer_load_dwordx4 v23, s[8:11], s31 offen sc1 lds
  s_add_u32 m0, s39, 8192
  s_nop 0
  buffer_load_dwordx4 v24, s[8:11], s31 offen sc1 lds
  s_add_u32 s31, s31, 10240
  s_add_u32 s36, s36, 1
  s_cmp_eq_u32 s36, 7
  s_cselect_b32 s35, s77, 18432
  s_cselect_b32 s36, 0, s36
  s_add_u32 s33, s33, s35
  s_add_u32 s39, s33, s62
  s_add_u32 m0, s39, 0
  s_nop 0
  buffer_load_dwordx4 v20, s[8:11], s31 offen sc1 lds
  s_add_u32 m0, s39, 2048
  s_nop 0
  buffer_load_dwordx4 v21, s[8:11], s31 offen sc1 lds
  s_add_u32 m0, s39, 4096
  s_nop 0
  buffer_load_dwordx4 v22, s[8:11], s31 offen sc1 lds
  s_add_u32 m0, s39, 6144
  s_nop 0
  buffer_load_dwordx4 v23, s[8:11], s31 offen sc1 lds
  s_add_u32 m0, s39, 8192
  s_nop 0
  buffer_load_dwordx4 v24, s[8:11], s31 offen sc1 lds
  s_add_u32 s31, s31, 10240
  s_add_u32 s36, s36, 1
  s_cmp_eq_u32 s36, 7
  s_cselect_b32 s35, s77, 18432
  s_cselect_b32 s36, 0, s36
  s_add_u32 s33, s33, s35
  s_add_u32 s39, s33, s62
  s_add_u32 m0, s39, 0
  s_nop 0
  buffer_load_dwordx4 v20, s[8:11], s31 offen sc1 lds
  s_add_u32 m0, s39, 2048
  s_nop 0
  buffer_load_dwordx4 v21, s[8:11], s31 offen sc1 lds
  s_add_u32 m0, s39, 4096
  s_nop 0
  buffer_load_dwordx4 v22, s[8:11], s31 offen sc1 lds
  s_add_u32 m0, s39, 6144
  s_nop 0
  buffer_load_dwordx4 v23, s[8:11], s31 offen sc1 lds
  s_add_u32 m0, s39, 8192
  s_nop 0
  buffer_load_dwordx4 v24, s[8:11], s31 offen sc1 lds
  s_add_u32 s31, s31, 10240
  s_add_u32 s36, s36, 1
  s_cmp_eq_u32 s36, 7
  s_cselect_b32 s35, s77, 18432
  s_cselect_b32 s36, 0, s36
  s_add_u32 s33, s33, s35
  s_add_u32 s39, s33, s62
  s_add_u32 m0, s39, 0
  s_nop 0
  buffer_load_dwordx4 v20, s[8:11], s31 offen sc1 lds
  s_add_u32 m0, s39, 2048
  s_nop 0
  buffer_load_dwordx4 v21, s[8:11], s31 offen sc1 lds
  s_add_u32 m0, s39, 4096
  s_nop 0
  buffer_load_dwordx4 v22, s[8:11], s31 offen sc1 lds
  s_add_u32 m0, s39, 6144
  s_nop 0
  buffer_load_dwordx4 v23, s[8:11], s31 offen sc1 lds
  s_add_u32 m0, s39, 8192
  s_nop 0
  buffer_load_dwordx4 v24, s[8:11], s31 offen sc1 lds
  s_add_u32 s31, s31, 10240
  s_add_u32 s36, s36, 1
  s_cmp_eq_u32 s36, 7
  s_cselect_b32 s35, s77, 18432
  s_cselect_b32 s36, 0, s36
  s_add_u32 s33, s33, s35
  s_waitcnt vmcnt(30)
  s_barrier
  s_waitcnt vmcnt(25)
  s_barrier
  s_mov_b32 s30, 0
L_p3_ll_71:
  s_waitcnt vmcnt(20)
  s_barrier
  s_add_u32 s39, s33, s62
  s_add_u32 m0, s39, 0
  s_nop 0
  buffer_load_dwordx4 v20, s[8:11], s31 offen sc1 lds
  s_add_u32 m0, s39, 2048
  s_nop 0
  buffer_load_dwordx4 v21, s[8:11], s31 offen sc1 lds
  s_add_u32 m0, s39, 4096
  s_nop 0
  buffer_load_dwordx4 v22, s[8:11], s31 offen sc1 lds
  s_add_u32 m0, s39, 6144
  s_nop 0
  buffer_load_dwordx4 v23, s[8:11], s31 offen sc1 lds
  s_add_u32 m0, s39, 8192
  s_nop 0
  buffer_load_dwordx4 v24, s[8:11], s31 offen sc1 lds
  s_add_u32 s31, s31, 10240
  s_add_u32 s36, s36, 1
  s_cmp_eq_u32 s36, 7
  s_cselect_b32 s35, s77, 18432
  s_cselect_b32 s36, 0, s36
  s_add_u32 s33, s33, s35
  s_add_u32 s30, s30, 1
  s_cmp_lt_u32 s30, 3
  s_cbranch_scc1 L_p3_ll_71
  s_waitcnt vmcnt(20)
  s_barrier
  s_waitcnt vmcnt(15)
  s_barrier
  s_waitcnt vmcnt(10)
  s_barrier
  s_waitcnt vmcnt(5)
  s_barrier
  s_waitcnt vmcnt(0)
  s_barrier
  s_branch L_p3_ldT_67
L_p3_ldA_66:
  s_lshl_b32 s62, s75, 10
  s_mul_i32 s39, s75, 32768
  s_lshl_b32 s40, s28, 4
  s_add_u32 s39, s39, s40
  v_lshl_add_u32 v20, v1, 4, s39
  v_add_u32 v21, 0x10000, v20
  v_add_u32 v22, 0x20000, v20
  v_add_u32 v23, 0x30000, v20
  s_add_u32 s4, s60, 0x800000
  s_addc_u32 s5, s61, 0
  s_and_b32 s5, s5, 0xffff
  s_mov_b32 s6, 0x280000
  s_mov_b32 s7, 0x20000
  s_mov_b32 s31, 0
  s_add_u32 s16, s60, 0x1a00000
  s_addc_u32 s17, s61, 0
  s_and_b32 s17, s17, 0xffff
  s_mov_b32 s18, 0x2000
  s_mov_b32 s19, 0x20000
  s_lshl_b32 s39, s21, 7
  s_add_u32 s39, s39, 2048
  v_lshl_add_u32 v4, v1, 3, s39
  s_mov_b32 exec_lo, 0xffff
  s_mov_b32 exec_hi, 0x0
  s_mov_b32 s86, 0
L_poll_73:
  buffer_load_dwordx2 v[12:13], v4, s[16:19], 0 offen sc1
  s_waitcnt vmcnt(0)
  v_xor_b32 v12, s90, v12
  v_xor_b32 v13, s91, v13
  v_or_b32 v12, v12, v13
  v_cmp_eq_u32 vcc, 0, v12
  s_add_u32 s86, s86, 1
  s_cmp_eq_u64 vcc, exec
  s_cbranch_scc1 L_pdone_74
  s_sleep 4
  s_cmp_lt_u32 s86, 0x40000
  s_cbranch_scc1 L_poll_73
L_pdone_74:
  s_mov_b64 exec, -1
L_pskip_72:
  s_add_u32 s39, s33, s62
  s_add_u32 m0, s39, 0
  s_nop 0
  buffer_load_dwordx4 v20, s[4:7], s31 offen sc1 lds
  s_add_u32 m0, s39, 2048
  s_nop 0
  buffer_load_dwordx4 v21, s[4:7], s31 offen sc1 lds
  s_add_u32 m0, s39, 4096
  s_nop 0
  buffer_load_dwordx4 v22, s[4:7], s31 offen sc1 lds
  s_add_u32 m0, s39, 6144
  s_nop 0
  buffer_load_dwordx4 v23, s[4:7], s31 offen sc1 lds
  s_add_u32 s31, s31, 262144
  s_add_u32 s36, s36, 1
  s_cmp_eq_u32 s36, 7
  s_cselect_b32 s35, s77, 18432
  s_cselect_b32 s36, 0, s36
  s_add_u32 s33, s33, s35
  s_add_u32 s39, s33, s62
  s_add_u32 m0, s39, 0
  s_nop 0
  buffer_load_dwordx4 v20, s[4:7], s31 offen sc1 lds
  s_add_u32 m0, s39, 2048
  s_nop 0
  buffer_load_dwordx4 v21, s[4:7], s31 offen sc1 lds
  s_add_u32 m0, s39, 4096
  s_nop 0
  buffer_load_dwordx4 v22, s[4:7], s31 offen sc1 lds
  s_add_u32 m0, s39, 6144
  s_nop 0
  buffer_load_dwordx4 v23, s[4:7], s31 offen sc1 lds
  s_add_u32 s31, s31, 262144
  s_add_u32 s36, s36, 1
  s_cmp_eq_u32 s36, 7
  s_cselect_b32 s35, s77, 18432
  s_cselect_b32 s36, 0, s36
  s_add_u32 s33, s33, s35
  s_waitcnt vmcnt(4)
  s_barrier
  s_add_u32 s39, s33, s62
  s_add_u32 m0, s39, 0
  s_nop 0
  buffer_load_dwordx4 v20, s[4:7], s31 offen sc1 lds
  s_add_u32 m0, s39, 2048
  s_nop 0
  buffer_load_dwordx4 v21, s[4:7], s31 offen sc1 lds
  s_add_u32 m0, s39, 4096
  s_nop 0
  buffer_load_dwordx4 v22, s[4:7], s31 offen sc1 lds
  s_add_u32 m0, s39, 6144
  s_nop 0
  buffer_load_dwordx4 v23, s[4:7], s31 offen sc1 lds
  s_add_u32 s31, s31, 262144
  s_add_u32 s36, s36, 1
  s_cmp_eq_u32 s36, 7
  s_cselect_b32 s35, s77, 18432
  s_cselect_b32 s36, 0, s36
  s_add_u32 s33, s33, s35
  s_add_u32 s39, s33, s62
  s_add_u32 m0, s39, 0
  s_nop 0
  buffer_load_dwordx4 v20, s[4:7], s31 offen sc1 lds
  s_add_u32 m0, s39, 2048
  s_nop 0
  buffer_load_dwordx4 v21, s[4:7], s31 offen sc1 lds
  s_add_u32 m0, s39, 4096
  s_nop 0
  buffer_load_dwordx4 v22, s[4:7], s31 offen sc1 lds
  s_add_u32 m0, s39, 6144
  s_nop 0
  buffer_load_dwordx4 v23, s[4:7], s31 offen sc1 lds
  s_add_u32 s31, s31, 262144
  s_add_u32 s36, s36, 1
  s_cmp_eq_u32 s36, 7
  s_cselect_b32 s35, s77, 18432
  s_cselect_b32 s36, 0, s36
  s_add_u32 s33, s33, s35
  s_waitcnt vmcnt(8)
  s_barrier
  s_add_u32 s39, s33, s62
  s_add_u32 m0, s39, 0
  s_nop 0
  buffer_load_dwordx4 v20, s[4:7], s31 offen sc1 lds
  s_add_u32 m0, s39, 2048
  s_nop 0
  buffer_load_dwordx4 v21, s[4:7], s31 offen sc1 lds
  s_add_u32 m0, s39, 4096
  s_nop 0
  buffer_load_dwordx4 v22, s[4:7], s31 offen sc1 lds
  s_add_u32 m0, s39, 6144
  s_nop 0
  buffer_load_dwordx4 v23, s[4:7], s31 offen sc1 lds
  s_add_u32 s31, s31, 262144
  s_add_u32 s36, s36, 1
  s_cmp_eq_u32 s36, 7
  s_cselect_b32 s35, s77, 18432
  s_cselect_b32 s36, 0, s36
  s_add_u32 s33, s33, s35
  s_add_u32 s39, s33, s62
  s_add_u32 m0, s39, 0
  s_nop 0
  buffer_load_dwordx4 v20, s[4:7], s31 offen sc1 lds
  s_add_u32 m0, s39, 2048
  s_nop 0
  buffer_load_dwordx4 v21, s[4:7], s31 offen sc1 lds
  s_add_u32 m0, s39, 4096
  s_nop 0
  buffer_load_dwordx4 v22, s[4:7], s31 offen sc1 lds
  s_add_u32 m0, s39, 6144
  s_nop 0
  buffer_load_dwordx4 v23, s[4:7], s31 offen sc1 lds
  s_add_u32 s31, s31, 262144
  s_add_u32 s36, s36, 1
  s_cmp_eq_u32 s36, 7
  s_cselect_b32 s35, s77, 18432
  s_cselect_b32 s36, 0, s36
  s_add_u32 s33, s33, s35
  s_waitcnt vmcnt(12)
  s_barrier
  s_add_u32 s39, s33, s62
  s_add_u32 m0, s39, 0
  s_nop 0
  buffer_load_dwordx4 v20, s[4:7], s31 offen sc1 lds
  s_add_u32 m0, s39, 2048
  s_nop 0
  buffer_load_dwordx4 v21, s[4:7], s31 offen sc1 lds
  s_add_u32 m0, s39, 4096
  s_nop 0
  buffer_load_dwordx4 v22, s[4:7], s31 offen sc1 lds
  s_add_u32 m0, s39, 6144
  s_nop 0
  buffer_load_dwordx4 v23, s[4:7], s31 offen sc1 lds
  s_add_u32 s31, s31, 262144
  s_add_u32 s36, s36, 1
  s_cmp_eq_u32 s36, 7
  s_cselect_b32 s35, s77, 18432
  s_cselect_b32 s36, 0, s36
  s_add_u32 s33, s33, s35
  s_add_u32 s39, s33, s62
  s_add_u32 m0, s39, 0
  s_nop 0
  buffer_load_dwordx4 v20, s[4:7], s31 offen sc1 lds
  s_add_u32 m0, s39, 2048
  s_nop 0
  buffer_load_dwordx4 v21, s[4:7], s31 offen sc1 lds
  s_add_u32 m0, s39, 4096
  s_nop 0
  buffer_load_dwordx4 v22, s[4:7], s31 offen sc1 lds
  s_add_u32 m0, s39, 6144
  s_nop 0
  buffer_load_dwordx4 v23, s[4:7], s31 offen sc1 lds
  s_add_u32 s31, s31, 262144
  s_add_u32 s36, s36, 1
  s_cmp_eq_u32 s36, 7
  s_cselect_b32 s35, s77, 18432
  s_cselect_b32 s36, 0, s36
  s_add_u32 s33, s33, s35
  s_waitcnt vmcnt(16)
  s_barrier
  s_add_u32 s39, s33, s62
  s_add_u32 m0, s39, 0
  s_nop 0
  buffer_load_dwordx4 v20, s[4:7], s31 offen sc1 lds
  s_add_u32 m0, s39, 2048
  s_nop 0
  buffer_load_dwordx4 v21, s[4:7], s31 offen sc1 lds
  s_add_u32 m0, s39, 4096
  s_nop 0
  buffer_load_dwordx4 v22, s[4:7], s31 offen sc1 lds
  s_add_u32 m0, s39, 6144
  s_nop 0
  buffer_load_dwordx4 v23, s[4:7], s31 offen sc1 lds
  s_add_u32 s31, s31, 262144
  s_add_u32 s36, s36, 1
  s_cmp_eq_u32 s36, 7
  s_cselect_b32 s35, s77, 18432
  s_cselect_b32 s36, 0, s36
  s_add_u32 s33, s33, s35
  s_waitcnt vmcnt(16)
  s_barrier
  s_add_u32 s39, s33, s62
  s_add_u32 m0, s39, 0
  s_nop 0
  buffer_load_dwordx4 v20, s[4:7], s31 offen sc1 lds
  s_add_u32 m0, s39, 2048
  s_nop 0
  buffer_load_dwordx4 v21, s[4:7], s31 offen sc1 lds
  s_add_u32 m0, s39, 4096
  s_nop 0
  buffer_load_dwordx4 v22, s[4:7], s31 offen sc1 lds
  s_add_u32 m0, s39, 6144
  s_nop 0
  buffer_load_dwordx4 v23, s[4:7], s31 offen sc1 lds
  s_add_u32 s31, s31, 262144
  s_add_u32 s36, s36, 1
  s_cmp_eq_u32 s36, 7
  s_cselect_b32 s35, s77, 18432
  s_cselect_b32 s36, 0, s36
  s_add_u32 s33, s33, s35
  s_waitcnt vmcnt(16)
  s_barrier
  s_waitcnt vmcnt(12)
  s_barrier
  s_waitcnt vmcnt(8)
  s_barrier
  s_waitcnt vmcnt(4)
  s_barrier
  s_waitcnt vmcnt(0)
  s_barrier
L_p3_ldT_67:
  s_barrier
  s_barrier
L_p3_join_63:
  s_cmp_ge_u32 s22, 14
  s_cbranch_scc1 L_p5_75
  s_lshl_b32 s28, s21, 7
  s_mov_b32 s38, s22
  s_lshl_b32 s29, s22, 7
  s_mov_b32 s77, -131072
  s_mov_b32 s36, 0
  s_mov_b32 s30, 0
  s_cmp_ge_u32 s20, 4
  s_cbranch_scc1 L_p4_ld_76
  s_lshr_b32 s74, s23, 1
  s_and_b32 s75, s23, 1
  v_mul_u32_u24 v28, 2048, v2
  v_lshl_add_u32 v28, v3, 4, v28
  s_mul_i32 s39, s74, 1024
  v_add_u32 v28, s39, v28
  s_mul_i32 s39, s75, 512
  v_sub_u32 v29, v28, s39
  v_add_u32 v28, s39, v28
  v_lshrrev_b32 v4, 2, v3
  v_and_b32 v5, 3, v3
  v_and_b32 v6, 1, v2
  v_lshl_add_u32 v6, v6, 2, v4
  v_lshl_add_u32 v4, v2, 3, v4
  v_lshlrev_b32 v4, 8, v4
  v_lshl_add_u32 v4, v5, 3, v4
  v_add_u32 v4, 16384, v4
  s_lshl_b32 s39, s74, 1
  s_add_u32 s39, s39, 0
  s_and_b32 s39, s39, 3
  s_lshl_b32 s40, s75, 2
  s_add_u32 s39, s39, s40
  v_xor_b32 v30, s39, v6
  v_lshl_add_u32 v30, v30, 5, v4
  s_lshl_b32 s39, s74, 1
  s_add_u32 s39, s39, 1
  s_and_b32 s39, s39, 3
  s_lshl_b32 s40, s75, 2
  s_add_u32 s39, s39, s40
  v_xor_b32 v31, s39, v6
  v_lshl_add_u32 v31, v31, 5, v4
  s_lshl_b32 s39, s74, 1
  s_add_u32 s39, s39, 2
  s_and_b32 s39, s39, 3
  s_lshl_b32 s40, s75, 2
  s_add_u32 s39, s39, s40
  v_xor_b32 v32, s39, v6
  v_lshl_add_u32 v32, v32, 5, v4
  s_lshl_b32 s39, s74, 1
  s_add_u32 s39, s39, 3
  s_and_b32 s39, s39, 3
  s_lshl_b32 s40, s75, 2
  s_add_u32 s39, s39, s40
  v_xor_b32 v33, s39, v6
  v_lshl_add_u32 v33, v33, 5, v4
  v_mov_b32 v36, 0
  v_mov_b32 v37, 0
  v_mov_b32 v38, 0
  v_mov_b32 v39, 0
  v_mov_b32 v40, 0
  v_mov_b32 v41, 0
  v_mov_b32 v42, 0
  v_mov_b32 v43, 0
  v_mov_b32 v44, 0
  v_mov_b32 v45, 0
  v_mov_b32 v46, 0
  v_mov_b32 v47, 0
  v_mov_b32 v48, 0
  v_mov_b32 v49, 0
  v_mov_b32 v50, 0
  v_mov_b32 v51, 0
  v_mov_b32 v52, 0
  v_mov_b32 v53, 0
  v_mov_b32 v54, 0
  v_mov_b32 v55, 0
  v_mov_b32 v56, 0
  v_mov_b32 v57, 0
  v_mov_b32 v58, 0
  v_mov_b32 v59, 0
  v_mov_b32 v60, 0
  v_mov_b32 v61, 0
  v_mov_b32 v62, 0
  v_mov_b32 v63, 0
  v_mov_b32 v64, 0
  v_mov_b32 v65, 0
  v_mov_b32 v66, 0
  v_mov_b32 v67, 0
  v_mov_b32 v68, 0
  v_mov_b32 v69, 0
  v_mov_b32 v70, 0
  v_mov_b32 v71, 0
  v_mov_b32 v72, 0
  v_mov_b32 v73, 0
  v_mov_b32 v74, 0
  v_mov_b32 v75, 0
  v_mov_b32 v76, 0
  v_mov_b32 v77, 0
  v_mov_b32 v78, 0
  v_mov_b32 v79, 0
  v_mov_b32 v80, 0
  v_mov_b32 v81, 0
  v_mov_b32 v82, 0
  v_mov_b32 v83, 0
  v_mov_b32 v84, 0
  v_mov_b32 v85, 0
  v_mov_b32 v86, 0
  v_mov_b32 v87, 0
  v_mov_b32 v88, 0
  v_mov_b32 v89, 0
  v_mov_b32 v90, 0
  v_mov_b32 v91, 0
  v_mov_b32 v92, 0
  v_mov_b32 v93, 0
  v_mov_b32 v94, 0
  v_mov_b32 v95, 0
  v_mov_b32 v96, 0
  v_mov_b32 v97, 0
  v_mov_b32 v98, 0
  v_mov_b32 v99, 0
  v_mov_b32 v228, 0x3f803f80
  v_mov_b32 v229, 0x3f803f80
  v_mov_b32 v230, 0x3f803f80
  v_mov_b32 v231, 0x3f803f80
  v_mov_b32 v232, 0
  v_mov_b32 v233, 0
  v_mov_b32 v234, 0
  v_mov_b32 v235, 0
  v_mov_b32 v236, 0
  v_mov_b32 v237, 0
  v_mov_b32 v238, 0
  v_mov_b32 v239, 0
  s_add_u32 s12, s60, 0xe00000
  s_addc_u32 s13, s61, 0
  s_and_b32 s13, s13, 0xffff
  s_mov_b32 s14, 0x6c0000
  s_mov_b32 s15, 0x20000
  s_barrier
  ds_read_b64_tr_b16 v[164:165], v30 offset:0
  ds_read_b64_tr_b16 v[166:167], v30 offset:1024
  ds_read_b64_tr_b16 v[168:169], v31 offset:0
  ds_read_b64_tr_b16 v[170:171], v31 offset:1024
  ds_read_b64_tr_b16 v[172:173], v32 offset:0
  ds_read_b64_tr_b16 v[174:175], v32 offset:1024
  ds_read_b64_tr_b16 v[176:177], v33 offset:0
  ds_read_b64_tr_b16 v[178:179], v33 offset:1024
  ds_read_b128 v[100:103], v28 offset:0
  ds_read_b128 v[104:107], v28 offset:256
  ds_read_b128 v[108:111], v29 offset:512
  ds_read_b128 v[112:115], v29 offset:768
  ds_read_b64_tr_b16 v[180:181], v30 offset:8192
  ds_read_b64_tr_b16 v[182:183], v30 offset:9216
  ds_read_b64_tr_b16 v[184:185], v31 offset:8192
  ds_read_b64_tr_b16 v[186:187], v31 offset:9216
  ds_read_b64_tr_b16 v[188:189], v32 offset:8192
  ds_read_b64_tr_b16 v[190:191], v32 offset:9216
  ds_read_b64_tr_b16 v[192:193], v33 offset:8192
  ds_read_b64_tr_b16 v[194:195], v33 offset:9216
  ds_read_b128 v[116:119], v28 offset:8192
  ds_read_b128 v[120:123], v28 offset:8448
  ds_read_b128 v[124:127], v29 offset:8704
  ds_read_b128 v[128:131], v29 offset:8960
L_p4_loop_78:
  s_barrier
  s_add_u32 s36, s36, 1
  s_cmp_eq_u32 s36, 5
  s_cselect_b32 s35, s77, 32768
  s_cselect_b32 s36, 0, s36
  v_add_u32 v28, s35, v28
  v_add_u32 v29, s35, v29
  v_add_u32 v30, s35, v30
  v_add_u32 v31, s35, v31
  v_add_u32 v32, s35, v32
  v_add_u32 v33, s35, v33
  s_waitcnt lgkmcnt(0)
  ds_read_b64_tr_b16 v[196:197], v30 offset:0
  ds_read_b64_tr_b16 v[198:199], v30 offset:1024
  v_mfma_f32_16x16x32_bf16 v[36:39], v[164:167], v[100:103], v[36:39]
  ds_read_b64_tr_b16 v[200:201], v31 offset:0
  ds_read_b64_tr_b16 v[202:203], v31 offset:1024
  v_mfma_f32_16x16x32_bf16 v[40:43], v[168:171], v[100:103], v[40:43]
  ds_read_b64_tr_b16 v[204:205], v32 offset:0
  ds_read_b64_tr_b16 v[206:207], v32 offset:1024
  v_mfma_f32_16x16x32_bf16 v[44:47], v[172:175], v[100:103], v[44:47]
  ds_read_b64_tr_b16 v[208:209], v33 offset:0
  ds_read_b64_tr_b16 v[210:211], v33 offset:1024
  v_mfma_f32_16x16x32_bf16 v[48:51], v[176:179], v[100:103], v[48:51]
  ds_read_b128 v[132:135], v28 offset:0
  ds_read_b128 v[136:139], v28 offset:256
  v_mfma_f32_16x16x32_bf16 v[52:55], v[164:167], v[104:107], v[52:55]
  ds_read_b128 v[140:143], v29 offset:512
  ds_read_b128 v[144:147], v29 offset:768
  v_mfma_f32_16x16x32_bf16 v[56:59], v[168:171], v[104:107], v[56:59]
  ds_read_b64_tr_b16 v[212:213], v30 offset:8192
  ds_read_b64_tr_b16 v[214:215], v30 offset:9216
  v_mfma_f32_16x16x32_bf16 v[60:63], v[172:175], v[104:107], v[60:63]
  ds_read_b64_tr_b16 v[216:217], v31 offset:8192
  ds_read_b64_tr_b16 v[218:219], v31 offset:9216
  v_mfma_f32_16x16x32_bf16 v[64:67], v[176:179], v[104:107], v[64:67]
  ds_read_b64_tr_b16 v[220:221], v32 offset:8192
  ds_read_b64_tr_b16 v[222:223], v32 offset:9216
  v_mfma_f32_16x16x32_bf16 v[68:71], v[164:167], v[108:111], v[68:71]
  ds_read_b64_tr_b16 v[224:225], v33 offset:8192
  ds_read_b64_tr_b16 v[226:227], v33 offset:9216
  v_mfma_f32_16x16x32_bf16 v[72:75], v[168:171], v[108:111], v[72:75]
  ds_read_b128 v[148:151], v28 offset:8192
  ds_read_b128 v[152:155], v28 offset:8448
  v_mfma_f32_16x16x32_bf16 v[76:79], v[172:175], v[108:111], v[76:79]
  ds_read_b128 v[156:159], v29 offset:8704
  ds_read_b128 v[160:163], v29 offset:8960
  v_mfma_f32_16x16x32_bf16 v[80:83], v[176:179], v[108:111], v[80:83]
  v_mfma_f32_16x16x32_bf16 v[84:87], v[164:167], v[112:115], v[84:87]
  v_mfma_f32_16x16x32_bf16 v[88:91], v[168:171], v[112:115], v[88:91]
  v_mfma_f32_16x16x32_bf16 v[92:95], v[172:175], v[112:115], v[92:95]
  v_mfma_f32_16x16x32_bf16 v[96:99], v[176:179], v[112:115], v[96:99]
  v_mfma_f32_16x16x32_bf16 v[232:235], v[164:167], v[228:231], v[232:235]
  v_mfma_f32_16x16x32_bf16 v[236:239], v[168:171], v[228:231], v[236:239]
  v_mfma_f32_16x16x32_bf16 v[36:39], v[180:183], v[116:119], v[36:39]
  v_mfma_f32_16x16x32_bf16 v[40:43], v[184:187], v[116:119], v[40:43]
  v_mfma_f32_16x16x32_bf16 v[44:47], v[188:191], v[116:119], v[44:47]
  v_mfma_f32_16x16x32_bf16 v[48:51], v[192:195], v[116:119], v[48:51]
  v_mfma_f32_16x16x32_bf16 v[52:55], v[180:183], v[120:123], v[52:55]
  v_mfma_f32_16x16x32_bf16 v[56:59], v[184:187], v[120:123], v[56:59]
  v_mfma_f32_16x16x32_bf16 v[60:63], v[188:191], v[120:123], v[60:63]
  v_mfma_f32_16x16x32_bf16 v[64:67], v[192:195], v[120:123], v[64:67]
  v_mfma_f32_16x16x32_bf16 v[68:71], v[180:183], v[124:127], v[68:71]
  v_mfma_f32_16x16x32_bf16 v[72:75], v[184:187], v[124:127], v[72:75]
  v_mfma_f32_16x16x32_bf16 v[76:79], v[188:191], v[124:127], v[76:79]
  v_mfma_f32_16x16x32_bf16 v[80:83], v[192:195], v[124:127], v[80:83]
  v_mfma_f32_16x16x32_bf16 v[84:87], v[180:183], v[128:131], v[84:87]
  v_mfma_f32_16x16x32_bf16 v[88:91], v[184:187], v[128:131], v[88:91]
  v_mfma_f32_16x16x32_bf16 v[92:95], v[188:191], v[128:131], v[92:95]
  v_mfma_f32_16x16x32_bf16 v[96:99], v[192:195], v[128:131], v[96:99]
  v_mfma_f32_16x16x32_bf16 v[232:235], v[180:183], v[228:231], v[232:235]
  v_mfma_f32_16x16x32_bf16 v[236:239], v[184:187], v[228:231], v[236:239]
  s_barrier
  s_add_u32 s36, s36, 1
  s_cmp_eq_u32 s36, 5
  s_cselect_b32 s35, s77, 32768
  s_cselect_b32 s36, 0, s36
  v_add_u32 v28, s35, v28
  v_add_u32 v29, s35, v29
  v_add_u32 v30, s35, v30
  v_add_u32 v31, s35, v31
  v_add_u32 v32, s35, v32
  v_add_u32 v33, s35, v33
  s_waitcnt lgkmcnt(0)
  ds_read_b64_tr_b16 v[164:165], v30 offset:0
  ds_read_b64_tr_b16 v[166:167], v30 offset:1024
  v_mfma_f32_16x16x32_bf16 v[36:39], v[196:199], v[132:135], v[36:39]
  ds_read_b64_tr_b16 v[168:169], v31 offset:0
  ds_read_b64_tr_b16 v[170:171], v31 offset:1024
  v_mfma_f32_16x16x32_bf16 v[40:43], v[200:203], v[132:135], v[40:43]
  ds_read_b64_tr_b16 v[172:173], v32 offset:0
  ds_read_b64_tr_b16 v[174:175], v32 offset:1024
  v_mfma_f32_16x16x32_bf16 v[44:47], v[204:207], v[132:135], v[44:47]
  ds_read_b64_tr_b16 v[176:177], v33 offset:0
  ds_read_b64_tr_b16 v[178:179], v33 offset:1024
  v_mfma_f32_16x16x32_bf16 v[48:51], v[208:211], v[132:135], v[48:51]
  ds_read_b128 v[100:103], v28 offset:0
  ds_read_b128 v[104:107], v28 offset:256
  v_mfma_f32_16x16x32_bf16 v[52:55], v[196:199], v[136:139], v[52:55]
  ds_read_b128 v[108:111], v29 offset:512
  ds_read_b128 v[112:115], v29 offset:768
  v_mfma_f32_16x16x32_bf16 v[56:59], v[200:203], v[136:139], v[56:59]
  ds_read_b64_tr_b16 v[180:181], v30 offset:8192
  ds_read_b64_tr_b16 v[182:183], v30 offset:9216
  v_mfma_f32_16x16x32_bf16 v[60:63], v[204:207], v[136:139], v[60:63]
  ds_read_b64_tr_b16 v[184:185], v31 offset:8192
  ds_read_b64_tr_b16 v[186:187], v31 offset:9216
  v_mfma_f32_16x16x32_bf16 v[64:67], v[208:211], v[136:139], v[64:67]
  ds_read_b64_tr_b16 v[188:189], v32 offset:8192
  ds_read_b64_tr_b16 v[190:191], v32 offset:9216
  v_mfma_f32_16x16x32_bf16 v[68:71], v[196:199], v[140:143], v[68:71]
  ds_read_b64_tr_b16 v[192:193], v33 offset:8192
  ds_read_b64_tr_b16 v[194:195], v33 offset:9216
  v_mfma_f32_16x16x32_bf16 v[72:75], v[200:203], v[140:143], v[72:75]
  ds_read_b128 v[116:119], v28 offset:8192
  ds_read_b128 v[120:123], v28 offset:8448
  v_mfma_f32_16x16x32_bf16 v[76:79], v[204:207], v[140:143], v[76:79]
  ds_read_b128 v[124:127], v29 offset:8704
  ds_read_b128 v[128:131], v29 offset:8960
  v_mfma_f32_16x16x32_bf16 v[80:83], v[208:211], v[140:143], v[80:83]
  v_mfma_f32_16x16x32_bf16 v[84:87], v[196:199], v[144:147], v[84:87]
  v_mfma_f32_16x16x32_bf16 v[88:91], v[200:203], v[144:147], v[88:91]
  v_mfma_f32_16x16x32_bf16 v[92:95], v[204:207], v[144:147], v[92:95]
  v_mfma_f32_16x16x32_bf16 v[96:99], v[208:211], v[144:147], v[96:99]
  v_mfma_f32_16x16x32_bf16 v[232:235], v[196:199], v[228:231], v[232:235]
  v_mfma_f32_16x16x32_bf16 v[236:239], v[200:203], v[228:231], v[236:239]
  v_mfma_f32_16x16x32_bf16 v[36:39], v[212:215], v[148:151], v[36:39]
  v_mfma_f32_16x16x32_bf16 v[40:43], v[216:219], v[148:151], v[40:43]
  v_mfma_f32_16x16x32_bf16 v[44:47], v[220:223], v[148:151], v[44:47]
  v_mfma_f32_16x16x32_bf16 v[48:51], v[224:227], v[148:151], v[48:51]
  v_mfma_f32_16x16x32_bf16 v[52:55], v[212:215], v[152:155], v[52:55]
  v_mfma_f32_16x16x32_bf16 v[56:59], v[216:219], v[152:155], v[56:59]
  v_mfma_f32_16x16x32_bf16 v[60:63], v[220:223], v[152:155], v[60:63]
  v_mfma_f32_16x16x32_bf16 v[64:67], v[224:227], v[152:155], v[64:67]
  v_mfma_f32_16x16x32_bf16 v[68:71], v[212:215], v[156:159], v[68:71]
  v_mfma_f32_16x16x32_bf16 v[72:75], v[216:219], v[156:159], v[72:75]
  v_mfma_f32_16x16x32_bf16 v[76:79], v[220:223], v[156:159], v[76:79]
  v_mfma_f32_16x16x32_bf16 v[80:83], v[224:227], v[156:159], v[80:83]
  v_mfma_f32_16x16x32_bf16 v[84:87], v[212:215], v[160:163], v[84:87]
  v_mfma_f32_16x16x32_bf16 v[88:91], v[216:219], v[160:163], v[88:91]
  v_mfma_f32_16x16x32_bf16 v[92:95], v[220:223], v[160:163], v[92:95]
  v_mfma_f32_16x16x32_bf16 v[96:99], v[224:227], v[160:163], v[96:99]
  v_mfma_f32_16x16x32_bf16 v[232:235], v[212:215], v[228:231], v[232:235]
  v_mfma_f32_16x16x32_bf16 v[236:239], v[216:219], v[228:231], v[236:239]
  s_add_u32 s30, s30, 1
  s_cmp_lt_u32 s30, 4
  s_cbranch_scc1 L_p4_loop_78
  s_barrier
  s_add_u32 s36, s36, 1
  s_cmp_eq_u32 s36, 5
  s_cselect_b32 s35, s77, 32768
  s_cselect_b32 s36, 0, s36
  v_add_u32 v28, s35, v28
  v_add_u32 v29, s35, v29
  v_add_u32 v30, s35, v30
  v_add_u32 v31, s35, v31
  v_add_u32 v32, s35, v32
  v_add_u32 v33, s35, v33
  s_waitcnt lgkmcnt(0)
  ds_read_b64_tr_b16 v[196:197], v30 offset:0
  ds_read_b64_tr_b16 v[198:199], v30 offset:1024
  v_mfma_f32_16x16x32_bf16 v[36:39], v[164:167], v[100:103], v[36:39]
  ds_read_b64_tr_b16 v[200:201], v31 offset:0
  ds_read_b64_tr_b16 v[202:203], v31 offset:1024
  v_mfma_f32_16x16x32_bf16 v[40:43], v[168:171], v[100:103], v[40:43]
  ds_read_b64_tr_b16 v[204:205], v32 offset:0
  ds_read_b64_tr_b16 v[206:207], v32 offset:1024
  v_mfma_f32_16x16x32_bf16 v[44:47], v[172:175], v[100:103], v[44:47]
  ds_read_b64_tr_b16 v[208:209], v33 offset:0
  ds_read_b64_tr_b16 v[210:211], v33 offset:1024
  v_mfma_f32_16x16x32_bf16 v[48:51], v[176:179], v[100:103], v[48:51]
  ds_read_b128 v[132:135], v28 offset:0
  ds_read_b128 v[136:139], v28 offset:256
  v_mfma_f32_16x16x32_bf16 v[52:55], v[164:167], v[104:107], v[52:55]
  ds_read_b128 v[140:143], v29 offset:512
  ds_read_b128 v[144:147], v29 offset:768
  v_mfma_f32_16x16x32_bf16 v[56:59], v[168:171], v[104:107], v[56:59]
  ds_read_b64_tr_b16 v[212:213], v30 offset:8192
  ds_read_b64_tr_b16 v[214:215], v30 offset:9216
  v_mfma_f32_16x16x32_bf16 v[60:63], v[172:175], v[104:107], v[60:63]
  ds_read_b64_tr_b16 v[216:217], v31 offset:8192
  ds_read_b64_tr_b16 v[218:219], v31 offset:9216
  v_mfma_f32_16x16x32_bf16 v[64:67], v[176:179], v[104:107], v[64:67]
  ds_read_b64_tr_b16 v[220:221], v32 offset:8192
  ds_read_b64_tr_b16 v[222:223], v32 offset:9216
  v_mfma_f32_16x16x32_bf16 v[68:71], v[164:167], v[108:111], v[68:71]
  ds_read_b64_tr_b16 v[224:225], v33 offset:8192
  ds_read_b64_tr_b16 v[226:227], v33 offset:9216
  v_mfma_f32_16x16x32_bf16 v[72:75], v[168:171], v[108:111], v[72:75]
  ds_read_b128 v[148:151], v28 offset:8192
  ds_read_b128 v[152:155], v28 offset:8448
  v_mfma_f32_16x16x32_bf16 v[76:79], v[172:175], v[108:111], v[76:79]
  ds_read_b128 v[156:159], v29 offset:8704
  ds_read_b128 v[160:163], v29 offset:8960
  v_mfma_f32_16x16x32_bf16 v[80:83], v[176:179], v[108:111], v[80:83]
  v_mfma_f32_16x16x32_bf16 v[84:87], v[164:167], v[112:115], v[84:87]
  v_mfma_f32_16x16x32_bf16 v[88:91], v[168:171], v[112:115], v[88:91]
  v_mfma_f32_16x16x32_bf16 v[92:95], v[172:175], v[112:115], v[92:95]
  v_mfma_f32_16x16x32_bf16 v[96:99], v[176:179], v[112:115], v[96:99]
  v_mfma_f32_16x16x32_bf16 v[232:235], v[164:167], v[228:231], v[232:235]
  v_mfma_f32_16x16x32_bf16 v[236:239], v[168:171], v[228:231], v[236:239]
  v_mfma_f32_16x16x32_bf16 v[36:39], v[180:183], v[116:119], v[36:39]
  v_mfma_f32_16x16x32_bf16 v[40:43], v[184:187], v[116:119], v[40:43]
  v_mfma_f32_16x16x32_bf16 v[44:47], v[188:191], v[116:119], v[44:47]
  v_mfma_f32_16x16x32_bf16 v[48:51], v[192:195], v[116:119], v[48:51]
  v_mfma_f32_16x16x32_bf16 v[52:55], v[180:183], v[120:123], v[52:55]
  v_mfma_f32_16x16x32_bf16 v[56:59], v[184:187], v[120:123], v[56:59]
  v_mfma_f32_16x16x32_bf16 v[60:63], v[188:191], v[120:123], v[60:63]
  v_mfma_f32_16x16x32_bf16 v[64:67], v[192:195], v[120:123], v[64:67]
  v_mfma_f32_16x16x32_bf16 v[68:71], v[180:183], v[124:127], v[68:71]
  v_mfma_f32_16x16x32_bf16 v[72:75], v[184:187], v[124:127], v[72:75]
  v_mfma_f32_16x16x32_bf16 v[76:79], v[188:191], v[124:127], v[76:79]
  v_mfma_f32_16x16x32_bf16 v[80:83], v[192:195], v[124:127], v[80:83]
  v_mfma_f32_16x16x32_bf16 v[84:87], v[180:183], v[128:131], v[84:87]
  v_mfma_f32_16x16x32_bf16 v[88:91], v[184:187], v[128:131], v[88:91]
  v_mfma_f32_16x16x32_bf16 v[92:95], v[188:191], v[128:131], v[92:95]
  v_mfma_f32_16x16x32_bf16 v[96:99], v[192:195], v[128:131], v[96:99]
  v_mfma_f32_16x16x32_bf16 v[232:235], v[180:183], v[228:231], v[232:235]
  v_mfma_f32_16x16x32_bf16 v[236:239], v[184:187], v[228:231], v[236:239]
  s_waitcnt lgkmcnt(0)
  v_mfma_f32_16x16x32_bf16 v[36:39], v[196:199], v[132:135], v[36:39]
  v_mfma_f32_16x16x32_bf16 v[40:43], v[200:203], v[132:135], v[40:43]
  v_mfma_f32_16x16x32_bf16 v[44:47], v[204:207], v[132:135], v[44:47]
  v_mfma_f32_16x16x32_bf16 v[48:51], v[208:211], v[132:135], v[48:51]
  v_mfma_f32_16x16x32_bf16 v[52:55], v[196:199], v[136:139], v[52:55]
  v_mfma_f32_16x16x32_bf16 v[56:59], v[200:203], v[136:139], v[56:59]
  v_mfma_f32_16x16x32_bf16 v[60:63], v[204:207], v[136:139], v[60:63]
  v_mfma_f32_16x16x32_bf16 v[64:67], v[208:211], v[136:139], v[64:67]
  v_mfma_f32_16x16x32_bf16 v[68:71], v[196:199], v[140:143], v[68:71]
  v_mfma_f32_16x16x32_bf16 v[72:75], v[200:203], v[140:143], v[72:75]
  v_mfma_f32_16x16x32_bf16 v[76:79], v[204:207], v[140:143], v[76:79]
  v_mfma_f32_16x16x32_bf16 v[80:83], v[208:211], v[140:143], v[80:83]
  v_mfma_f32_16x16x32_bf16 v[84:87], v[196:199], v[144:147], v[84:87]
  v_mfma_f32_16x16x32_bf16 v[88:91], v[200:203], v[144:147], v[88:91]
  v_mfma_f32_16x16x32_bf16 v[92:95], v[204:207], v[144:147], v[92:95]
  v_mfma_f32_16x16x32_bf16 v[96:99], v[208:211], v[144:147], v[96:99]
  v_mfma_f32_16x16x32_bf16 v[232:235], v[196:199], v[228:231], v[232:235]
  v_mfma_f32_16x16x32_bf16 v[236:239], v[200:203], v[228:231], v[236:239]
  v_mfma_f32_16x16x32_bf16 v[36:39], v[212:215], v[148:151], v[36:39]
  v_mfma_f32_16x16x32_bf16 v[40:43], v[216:219], v[148:151], v[40:43]
  v_mfma_f32_16x16x32_bf16 v[44:47], v[220:223], v[148:151], v[44:47]
  v_mfma_f32_16x16x32_bf16 v[48:51], v[224:227], v[148:151], v[48:51]
  v_mfma_f32_16x16x32_bf16 v[52:55], v[212:215], v[152:155], v[52:55]
  v_mfma_f32_16x16x32_bf16 v[56:59], v[216:219], v[152:155], v[56:59]
  v_mfma_f32_16x16x32_bf16 v[60:63], v[220:223], v[152:155], v[60:63]
  v_mfma_f32_16x16x32_bf16 v[64:67], v[224:227], v[152:155], v[64:67]
  v_mfma_f32_16x16x32_bf16 v[68:71], v[212:215], v[156:159], v[68:71]
  v_mfma_f32_16x16x32_bf16 v[72:75], v[216:219], v[156:159], v[72:75]
  v_mfma_f32_16x16x32_bf16 v[76:79], v[220:223], v[156:159], v[76:79]
  v_mfma_f32_16x16x32_bf16 v[80:83], v[224:227], v[156:159], v[80:83]
  v_mfma_f32_16x16x32_bf16 v[84:87], v[212:215], v[160:163], v[84:87]
  v_mfma_f32_16x16x32_bf16 v[88:91], v[216:219], v[160:163], v[88:91]
  v_mfma_f32_16x16x32_bf16 v[92:95], v[220:223], v[160:163], v[92:95]
  v_mfma_f32_16x16x32_bf16 v[96:99], v[224:227], v[160:163], v[96:99]
  v_mfma_f32_16x16x32_bf16 v[232:235], v[212:215], v[228:231], v[232:235]
  v_mfma_f32_16x16x32_bf16 v[236:239], v[216:219], v[228:231], v[236:239]
  s_nop 7
  s_lshl_b32 s39, s74, 6
  s_lshl_b32 s40, s75, 5
  s_add_u32 s39, s39, s40
  v_add_u32 v4, s39, v3
  v_lshlrev_b32 v4, 3, v4
  v_add_u32 v140, 65536, v4
  s_lshl_b32 s39, s75, 8
  s_lshl_b32 s40, s74, 7
  s_add_u32 s41, s39, s40
  s_sub_u32 s39, s39, s40
  v_lshlrev_b32 v5, 4, v2
  v_add_u32 v5, 66560, v5
  v_add_u32 v6, s39, v5
  v_add_u32 v5, s41, v5
  ds_write_b128 v5, v[232:235]
  ds_write_b128 v5, v[236:239] offset:64
  s_lshl_b32 s39, s75, 9
  v_sub_u32 v5, v140, s39
  s_waitcnt lgkmcnt(0)
  s_barrier
  ds_read_b64 v[100:101], v140 offset:0
  ds_read_b64 v[102:103], v140 offset:128
  ds_read_b64 v[104:105], v5 offset:256
  ds_read_b64 v[106:107], v5 offset:384
  ds_read_b128 v[132:135], v6 offset:128
  ds_read_b128 v[136:139], v6 offset:192
  s_mov_b32 s39, 0x3acccccd
  s_mov_b32 s40, 0x3727c5ac
  v_and_b32 v4, 1, v2
  v_lshlrev_b32 v4, 1, v4
  v_lshrrev_b32 v5, 1, v2
  v_add_u32 v4, v4, v5
  v_mul_u32_u24 v4, 32768, v4
  v_lshl_add_u32 v4, v3, 4, v4
  s_lshl_b32 s86, s74, 6
  s_add_u32 s86, s86, s28
  s_lshl_b32 s86, s86, 4
  s_lshl_b32 s87, s75, 9
  s_add_u32 s88, s86, s87
  s_sub_u32 s86, s86, s87
  v_add_u32 v140, s88, v4
  v_add_u32 v140, 0, v140
  v_add_u32 v141, s88, v4
  v_add_u32 v141, 256, v141
  v_add_u32 v142, s86, v4
  v_add_u32 v142, 512, v142
  v_add_u32 v143, s86, v4
  v_add_u32 v143, 768, v143
  s_lshr_b32 s86, s29, 3
  s_lshl_b32 s87, s75, 3
  s_add_u32 s86, s86, s87
  s_lshl_b32 s87, s74, 2
  s_add_u32 s70, s86, s87
  s_mul_i32 s70, s70, 32768
  s_sub_u32 s71, s86, s87
  s_add_u32 s71, s71, 4
  s_mul_i32 s71, s71, 32768
  s_waitcnt lgkmcnt(4)
  v_mul_f32 v100, s39, v100
  v_mul_f32 v101, s39, v101
  v_fma_f32 v101, -v100, v100, v101
  v_max_f32 v101, 0, v101
  v_add_f32 v101, s40, v101
  v_rsq_f32 v116, v101
  v_sub_f32 v108, 0, v100
  v_mul_f32 v102, s39, v102
  v_mul_f32 v103, s39, v103
  v_fma_f32 v103, -v102, v102, v103
  v_max_f32 v103, 0, v103
  v_add_f32 v103, s40, v103
  v_rsq_f32 v118, v103
  v_sub_f32 v110, 0, v102
  v_pk_fma_f32 v[36:37], v[232:233], v[108:109], v[36:37] op_sel_hi:[1,0,1]
  v_pk_fma_f32 v[38:39], v[234:235], v[108:109], v[38:39] op_sel_hi:[1,0,1]
  v_pk_mul_f32 v[36:37], v[36:37], v[116:117] op_sel_hi:[1,0]
  v_pk_mul_f32 v[38:39], v[38:39], v[116:117] op_sel_hi:[1,0]
  v_cvt_pk_bf16_f32 v144, v36, v37
  v_cvt_pk_bf16_f32 v145, v38, v39
  v_pk_max_i16 v144, v144, 0
  v_pk_max_i16 v145, v145, 0
  v_pk_fma_f32 v[40:41], v[236:237], v[108:109], v[40:41] op_sel_hi:[1,0,1]
  v_pk_fma_f32 v[42:43], v[238:239], v[108:109], v[42:43] op_sel_hi:[1,0,1]
  v_pk_mul_f32 v[40:41], v[40:41], v[116:117] op_sel_hi:[1,0]
  v_pk_mul_f32 v[42:43], v[42:43], v[116:117] op_sel_hi:[1,0]
  v_cvt_pk_bf16_f32 v146, v40, v41
  v_cvt_pk_bf16_f32 v147, v42, v43
  v_pk_max_i16 v146, v146, 0
  v_pk_max_i16 v147, v147, 0
  s_nop 1
  v_permlane16_swap_b32 v144, v146
  v_permlane16_swap_b32 v145, v147
  buffer_store_dwordx4 v[144:147], v140, s[12:15], s70 offen sc1
  v_pk_fma_f32 v[52:53], v[232:233], v[110:111], v[52:53] op_sel_hi:[1,0,1]
  v_pk_fma_f32 v[54:55], v[234:235], v[110:111], v[54:55] op_sel_hi:[1,0,1]
  v_pk_mul_f32 v[52:53], v[52:53], v[118:119] op_sel_hi:[1,0]
  v_pk_mul_f32 v[54:55], v[54:55], v[118:119] op_sel_hi:[1,0]
  v_cvt_pk_bf16_f32 v148, v52, v53
  v_cvt_pk_bf16_f32 v149, v54, v55
  v_pk_max_i16 v148, v148, 0
  v_pk_max_i16 v149, v149, 0
  v_pk_fma_f32 v[56:57], v[236:237], v[110:111], v[56:57] op_sel_hi:[1,0,1]
  v_pk_fma_f32 v[58:59], v[238:239], v[110:111], v[58:59] op_sel_hi:[1,0,1]
  v_pk_mul_f32 v[56:57], v[56:57], v[118:119] op_sel_hi:[1,0]
  v_pk_mul_f32 v[58:59], v[58:59], v[118:119] op_sel_hi:[1,0]
  v_cvt_pk_bf16_f32 v150, v56, v57
  v_cvt_pk_bf16_f32 v151, v58, v59
  v_pk_max_i16 v150, v150, 0
  v_pk_max_i16 v151, v151, 0
  s_nop 1
  v_permlane16_swap_b32 v148, v150
  v_permlane16_swap_b32 v149, v151
  buffer_store_dwordx4 v[148:151], v141, s[12:15], s70 offen sc1
  s_waitcnt lgkmcnt(0)
  v_mul_f32 v104, s39, v104
  v_mul_f32 v105, s39, v105
  v_fma_f32 v105, -v104, v104, v105
  v_max_f32 v105, 0, v105
  v_add_f32 v105, s40, v105
  v_rsq_f32 v120, v105
  v_sub_f32 v112, 0, v104
  v_mul_f32 v106, s39, v106
  v_mul_f32 v107, s39, v107
  v_fma_f32 v107, -v106, v106, v107
  v_max_f32 v107, 0, v107
  v_add_f32 v107, s40, v107
  v_rsq_f32 v122, v107
  v_sub_f32 v114, 0, v106
  v_pk_fma_f32 v[44:45], v[132:133], v[108:109], v[44:45] op_sel_hi:[1,0,1]
  v_pk_fma_f32 v[46:47], v[134:135], v[108:109], v[46:47] op_sel_hi:[1,0,1]
  v_pk_mul_f32 v[44:45], v[44:45], v[116:117] op_sel_hi:[1,0]
  v_pk_mul_f32 v[46:47], v[46:47], v[116:117] op_sel_hi:[1,0]
  v_cvt_pk_bf16_f32 v144, v44, v45
  v_cvt_pk_bf16_f32 v145, v46, v47
  v_pk_max_i16 v144, v144, 0
  v_pk_max_i16 v145, v145, 0
  v_pk_fma_f32 v[48:49], v[136:137], v[108:109], v[48:49] op_sel_hi:[1,0,1]
  v_pk_fma_f32 v[50:51], v[138:139], v[108:109], v[50:51] op_sel_hi:[1,0,1]
  v_pk_mul_f32 v[48:49], v[48:49], v[116:117] op_sel_hi:[1,0]
  v_pk_mul_f32 v[50:51], v[50:51], v[116:117] op_sel_hi:[1,0]
  v_cvt_pk_bf16_f32 v146, v48, v49
  v_cvt_pk_bf16_f32 v147, v50, v51
  v_pk_max_i16 v146, v146, 0
  v_pk_max_i16 v147, v147, 0
  s_nop 1
  v_permlane16_swap_b32 v144, v146
  v_permlane16_swap_b32 v145, v147
  buffer_store_dwordx4 v[144:147], v140, s[12:15], s71 offen sc1
  v_pk_fma_f32 v[60:61], v[132:133], v[110:111], v[60:61] op_sel_hi:[1,0,1]
  v_pk_fma_f32 v[62:63], v[134:135], v[110:111], v[62:63] op_sel_hi:[1,0,1]
  v_pk_mul_f32 v[60:61], v[60:61], v[118:119] op_sel_hi:[1,0]
  v_pk_mul_f32 v[62:63], v[62:63], v[118:119] op_sel_hi:[1,0]
  v_cvt_pk_bf16_f32 v148, v60, v61
  v_cvt_pk_bf16_f32 v149, v62, v63
  v_pk_max_i16 v148, v148, 0
  v_pk_max_i16 v149, v149, 0
  v_pk_fma_f32 v[64:65], v[136:137], v[110:111], v[64:65] op_sel_hi:[1,0,1]
  v_pk_fma_f32 v[66:67], v[138:139], v[110:111], v[66:67] op_sel_hi:[1,0,1]
  v_pk_mul_f32 v[64:65], v[64:65], v[118:119] op_sel_hi:[1,0]
  v_pk_mul_f32 v[66:67], v[66:67], v[118:119] op_sel_hi:[1,0]
  v_cvt_pk_bf16_f32 v150, v64, v65
  v_cvt_pk_bf16_f32 v151, v66, v67
  v_pk_max_i16 v150, v150, 0
  v_pk_max_i16 v151, v151, 0
  s_nop 1
  v_permlane16_swap_b32 v148, v150
  v_permlane16_swap_b32 v149, v151
  buffer_store_dwordx4 v[148:151], v141, s[12:15], s71 offen sc1
  v_pk_fma_f32 v[68:69], v[232:233], v[112:113], v[68:69] op_sel_hi:[1,0,1]
  v_pk_fma_f32 v[70:71], v[234:235], v[112:113], v[70:71] op_sel_hi:[1,0,1]
  v_pk_mul_f32 v[68:69], v[68:69], v[120:121] op_sel_hi:[1,0]
  v_pk_mul_f32 v[70:71], v[70:71], v[120:121] op_sel_hi:[1,0]
  v_cvt_pk_bf16_f32 v144, v68, v69
  v_cvt_pk_bf16_f32 v145, v70, v71
  v_pk_max_i16 v144, v144, 0
  v_pk_max_i16 v145, v145, 0
  v_pk_fma_f32 v[72:73], v[236:237], v[112:113], v[72:73] op_sel_hi:[1,0,1]
  v_pk_fma_f32 v[74:75], v[238:239], v[112:113], v[74:75] op_sel_hi:[1,0,1]
  v_pk_mul_f32 v[72:73], v[72:73], v[120:121] op_sel_hi:[1,0]
  v_pk_mul_f32 v[74:75], v[74:75], v[120:121] op_sel_hi:[1,0]
  v_cvt_pk_bf16_f32 v146, v72, v73
  v_cvt_pk_bf16_f32 v147, v74, v75
  v_pk_max_i16 v146, v146, 0
  v_pk_max_i16 v147, v147, 0
  s_nop 1
  v_permlane16_swap_b32 v144, v146
  v_permlane16_swap_b32 v145, v147
  buffer_store_dwordx4 v[144:147], v142, s[12:15], s70 offen sc1
  v_pk_fma_f32 v[76:77], v[132:133], v[112:113], v[76:77] op_sel_hi:[1,0,1]
  v_pk_fma_f32 v[78:79], v[134:135], v[112:113], v[78:79] op_sel_hi:[1,0,1]
  v_pk_mul_f32 v[76:77], v[76:77], v[120:121] op_sel_hi:[1,0]
  v_pk_mul_f32 v[78:79], v[78:79], v[120:121] op_sel_hi:[1,0]
  v_cvt_pk_bf16_f32 v148, v76, v77
  v_cvt_pk_bf16_f32 v149, v78, v79
  v_pk_max_i16 v148, v148, 0
  v_pk_max_i16 v149, v149, 0
  v_pk_fma_f32 v[80:81], v[136:137], v[112:113], v[80:81] op_sel_hi:[1,0,1]
  v_pk_fma_f32 v[82:83], v[138:139], v[112:113], v[82:83] op_sel_hi:[1,0,1]
  v_pk_mul_f32 v[80:81], v[80:81], v[120:121] op_sel_hi:[1,0]
  v_pk_mul_f32 v[82:83], v[82:83], v[120:121] op_sel_hi:[1,0]
  v_cvt_pk_bf16_f32 v150, v80, v81
  v_cvt_pk_bf16_f32 v151, v82, v83
  v_pk_max_i16 v150, v150, 0
  v_pk_max_i16 v151, v151, 0
  s_nop 1
  v_permlane16_swap_b32 v148, v150
  v_permlane16_swap_b32 v149, v151
  buffer_store_dwordx4 v[148:151], v142, s[12:15], s71 offen sc1
  v_pk_fma_f32 v[84:85], v[232:233], v[114:115], v[84:85] op_sel_hi:[1,0,1]
  v_pk_fma_f32 v[86:87], v[234:235], v[114:115], v[86:87] op_sel_hi:[1,0,1]
  v_pk_mul_f32 v[84:85], v[84:85], v[122:123] op_sel_hi:[1,0]
  v_pk_mul_f32 v[86:87], v[86:87], v[122:123] op_sel_hi:[1,0]
  v_cvt_pk_bf16_f32 v144, v84, v85
  v_cvt_pk_bf16_f32 v145, v86, v87
  v_pk_max_i16 v144, v144, 0
  v_pk_max_i16 v145, v145, 0
  v_pk_fma_f32 v[88:89], v[236:237], v[114:115], v[88:89] op_sel_hi:[1,0,1]
  v_pk_fma_f32 v[90:91], v[238:239], v[114:115], v[90:91] op_sel_hi:[1,0,1]
  v_pk_mul_f32 v[88:89], v[88:89], v[122:123] op_sel_hi:[1,0]
  v_pk_mul_f32 v[90:91], v[90:91], v[122:123] op_sel_hi:[1,0]
  v_cvt_pk_bf16_f32 v146, v88, v89
  v_cvt_pk_bf16_f32 v147, v90, v91
  v_pk_max_i16 v146, v146, 0
  v_pk_max_i16 v147, v147, 0
  s_nop 1
  v_permlane16_swap_b32 v144, v146
  v_permlane16_swap_b32 v145, v147
  buffer_store_dwordx4 v[144:147], v143, s[12:15], s70 offen sc1
  v_pk_fma_f32 v[92:93], v[132:133], v[114:115], v[92:93] op_sel_hi:[1,0,1]
  v_pk_fma_f32 v[94:95], v[134:135], v[114:115], v[94:95] op_sel_hi:[1,0,1]
  v_pk_mul_f32 v[92:93], v[92:93], v[122:123] op_sel_hi:[1,0]
  v_pk_mul_f32 v[94:95], v[94:95], v[122:123] op_sel_hi:[1,0]
  v_cvt_pk_bf16_f32 v148, v92, v93
  v_cvt_pk_bf16_f32 v149, v94, v95
  v_pk_max_i16 v148, v148, 0
  v_pk_max_i16 v149, v149, 0
  v_pk_fma_f32 v[96:97], v[136:137], v[114:115], v[96:97] op_sel_hi:[1,0,1]
  v_pk_fma_f32 v[98:99], v[138:139], v[114:115], v[98:99] op_sel_hi:[1,0,1]
  v_pk_mul_f32 v[96:97], v[96:97], v[122:123] op_sel_hi:[1,0]
  v_pk_mul_f32 v[98:99], v[98:99], v[122:123] op_sel_hi:[1,0]
  v_cvt_pk_bf16_f32 v150, v96, v97
  v_cvt_pk_bf16_f32 v151, v98, v99
  v_pk_max_i16 v150, v150, 0
  v_pk_max_i16 v151, v151, 0
  s_nop 1
  v_permlane16_swap_b32 v148, v150
  v_permlane16_swap_b32 v149, v151
  buffer_store_dwordx4 v[148:151], v143, s[12:15], s71 offen sc1
  s_waitcnt vmcnt(0)
  s_barrier
  s_cmp_lg_u32 s20, 0
  s_cbranch_scc1 L_sig_79
  s_add_u32 s16, s60, 0x1a00000
  s_addc_u32 s17, s61, 0
  s_and_b32 s17, s17, 0xffff
  s_mov_b32 s18, 0x2000
  s_mov_b32 s19, 0x20000
  s_lshl_b32 s39, s21, 7
  s_lshl_b32 s40, s22, 3
  s_add_u32 s39, s39, s40
  v_mov_b32 v4, 6144
  v_mov_b32 v12, s90
  v_mov_b32 v13, s91
  s_mov_b64 exec, 1
  buffer_store_dwordx2 v[12:13], v4, s[16:19], s39 offen sc1
  s_mov_b64 exec, -1
L_sig_79:
  s_branch L_p4_join_77
L_p4_ld_76:
  s_and_b32 s75, s23, 1
  s_mov_b32 s33, 0
  s_cmp_ge_u32 s23, 2
  s_cbranch_scc1 L_p4_ldA_80
  s_lshl_b32 s62, s75, 10
  s_add_u32 s62, s62, 16384
  v_lshlrev_b32 v4, 1, v2
  v_xor_b32 v4, v4, v3
  v_lshlrev_b32 v4, 4, v4
  v_xor_b32 v6, 128, v4
  s_lshl_b32 s39, s75, 2
  v_add_u32 v5, s39, v2
  v_mul_u32_u24 v5, 3456, v5
  s_lshl_b32 s39, s29, 1
  v_add3_u32 v20, v4, v5, s39
  v_add3_u32 v21, v6, v5, s39
  v_add_u32 v21, 27648, v21
  v_add_u32 v22, 55296, v20
  v_add_u32 v23, 55296, v21
  v_add_u32 v24, 110592, v20
  v_add_u32 v25, 110592, v21
  v_add_u32 v26, 165888, v20
  v_add_u32 v27, 165888, v21
  s_mov_b32 s8, s52
  s_and_b32 s9, s53, 0xffff
  s_mov_b32 s10, 0x21c000
  s_mov_b32 s11, 0x20000
  s_mov_b32 s31, 0
  s_add_u32 s39, s33, s62
  s_add_u32 m0, s39, 0
  s_nop 0
  buffer_load_dwordx4 v20, s[8:11], s31 offen lds
  s_add_u32 m0, s39, 2048
  s_nop 0
  buffer_load_dwordx4 v21, s[8:11], s31 offen lds
  s_add_u32 m0, s39, 4096
  s_nop 0
  buffer_load_dwordx4 v22, s[8:11], s31 offen lds
  s_add_u32 m0, s39, 6144
  s_nop 0
  buffer_load_dwordx4 v23, s[8:11], s31 offen lds
  s_add_u32 m0, s39, 8192
  s_nop 0
  buffer_load_dwordx4 v24, s[8:11], s31 offen lds
  s_add_u32 m0, s39, 10240
  s_nop 0
  buffer_load_dwordx4 v25, s[8:11], s31 offen lds
  s_add_u32 m0, s39, 12288
  s_nop 0
  buffer_load_dwordx4 v26, s[8:11], s31 offen lds
  s_add_u32 m0, s39, 14336
  s_nop 0
  buffer_load_dwordx4 v27, s[8:11], s31 offen lds
  s_add_u32 s31, s31, 221184
  s_add_u32 s36, s36, 1
  s_cmp_eq_u32 s36, 5
  s_cselect_b32 s35, s77, 32768
  s_cselect_b32 s36, 0, s36
  s_add_u32 s33, s33, s35
  s_add_u32 s39, s33, s62
  s_add_u32 m0, s39, 0
  s_nop 0
  buffer_load_dwordx4 v20, s[8:11], s31 offen lds
  s_add_u32 m0, s39, 2048
  s_nop 0
  buffer_load_dwordx4 v21, s[8:11], s31 offen lds
  s_add_u32 m0, s39, 4096
  s_nop 0
  buffer_load_dwordx4 v22, s[8:11], s31 offen lds
  s_add_u32 m0, s39, 6144
  s_nop 0
  buffer_load_dwordx4 v23, s[8:11], s31 offen lds
  s_add_u32 m0, s39, 8192
  s_nop 0
  buffer_load_dwordx4 v24, s[8:11], s31 offen lds
  s_add_u32 m0, s39, 10240
  s_nop 0
  buffer_load_dwordx4 v25, s[8:11], s31 offen lds
  s_add_u32 m0, s39, 12288
  s_nop 0
  buffer_load_dwordx4 v26, s[8:11], s31 offen lds
  s_add_u32 m0, s39, 14336
  s_nop 0
  buffer_load_dwordx4 v27, s[8:11], s31 offen lds
  s_add_u32 s31, s31, 221184
  s_add_u32 s36, s36, 1
  s_cmp_eq_u32 s36, 5
  s_cselect_b32 s35, s77, 32768
  s_cselect_b32 s36, 0, s36
  s_add_u32 s33, s33, s35
  s_add_u32 s39, s33, s62
  s_add_u32 m0, s39, 0
  s_nop 0
  buffer_load_dwordx4 v20, s[8:11], s31 offen lds
  s_add_u32 m0, s39, 2048
  s_nop 0
  buffer_load_dwordx4 v21, s[8:11], s31 offen lds
  s_add_u32 m0, s39, 4096
  s_nop 0
  buffer_load_dwordx4 v22, s[8:11], s31 offen lds
  s_add_u32 m0, s39, 6144
  s_nop 0
  buffer_load_dwordx4 v23, s[8:11], s31 offen lds
  s_add_u32 m0, s39, 8192
  s_nop 0
  buffer_load_dwordx4 v24, s[8:11], s31 offen lds
  s_add_u32 m0, s39, 10240
  s_nop 0
  buffer_load_dwordx4 v25, s[8:11], s31 offen lds
  s_add_u32 m0, s39, 12288
  s_nop 0
  buffer_load_dwordx4 v26, s[8:11], s31 offen lds
  s_add_u32 m0, s39, 14336
  s_nop 0
  buffer_load_dwordx4 v27, s[8:11], s31 offen lds
  s_add_u32 s31, s31, 221184
  s_add_u32 s36, s36, 1
  s_cmp_eq_u32 s36, 5
  s_cselect_b32 s35, s77, 32768
  s_cselect_b32 s36, 0, s36
  s_add_u32 s33, s33, s35
  s_add_u32 s39, s33, s62
  s_add_u32 m0, s39, 0
  s_nop 0
  buffer_load_dwordx4 v20, s[8:11], s31 offen lds
  s_add_u32 m0, s39, 2048
  s_nop 0
  buffer_load_dwordx4 v21, s[8:11], s31 offen lds
  s_add_u32 m0, s39, 4096
  s_nop 0
  buffer_load_dwordx4 v22, s[8:11], s31 offen lds
  s_add_u32 m0, s39, 6144
  s_nop 0
  buffer_load_dwordx4 v23, s[8:11], s31 offen lds
  s_add_u32 m0, s39, 8192
  s_nop 0
  buffer_load_dwordx4 v24, s[8:11], s31 offen lds
  s_add_u32 m0, s39, 10240
  s_nop 0
  buffer_load_dwordx4 v25, s[8:11], s31 offen lds
  s_add_u32 m0, s39, 12288
  s_nop 0
  buffer_load_dwordx4 v26, s[8:11], s31 offen lds
  s_add_u32 m0, s39, 14336
  s_nop 0
  buffer_load_dwordx4 v27, s[8:11], s31 offen lds
  s_add_u32 s31, s31, 221184
  s_add_u32 s36, s36, 1
  s_cmp_eq_u32 s36, 5
  s_cselect_b32 s35, s77, 32768
  s_cselect_b32 s36, 0, s36
  s_add_u32 s33, s33, s35
  s_add_u32 s39, s33, s62
  s_add_u32 m0, s39, 0
  s_nop 0
  buffer_load_dwordx4 v20, s[8:11], s31 offen lds
  s_add_u32 m0, s39, 2048
  s_nop 0
  buffer_load_dwordx4 v21, s[8:11], s31 offen lds
  s_add_u32 m0, s39, 4096
  s_nop 0
  buffer_load_dwordx4 v22, s[8:11], s31 offen lds
  s_add_u32 m0, s39, 6144
  s_nop 0
  buffer_load_dwordx4 v23, s[8:11], s31 offen lds
  s_add_u32 m0, s39, 8192
  s_nop 0
  buffer_load_dwordx4 v24, s[8:11], s31 offen lds
  s_add_u32 m0, s39, 10240
  s_nop 0
  buffer_load_dwordx4 v25, s[8:11], s31 offen lds
  s_add_u32 m0, s39, 12288
  s_nop 0
  buffer_load_dwordx4 v26, s[8:11], s31 offen lds
  s_add_u32 m0, s39, 14336
  s_nop 0
  buffer_load_dwordx4 v27, s[8:11], s31 offen lds
  s_add_u32 s31, s31, 221184
  s_add_u32 s36, s36, 1
  s_cmp_eq_u32 s36, 5
  s_cselect_b32 s35, s77, 32768
  s_cselect_b32 s36, 0, s36
  s_add_u32 s33, s33, s35
  s_waitcnt vmcnt(32)
  s_barrier
  s_waitcnt vmcnt(24)
  s_barrier
  s_mov_b32 s30, 0
L_p4_ll_82:
  s_waitcnt vmcnt(16)
  s_barrier
  s_add_u32 s39, s33, s62
  s_add_u32 m0, s39, 0
  s_nop 0
  buffer_load_dwordx4 v20, s[8:11], s31 offen lds
  s_add_u32 m0, s39, 2048
  s_nop 0
  buffer_load_dwordx4 v21, s[8:11], s31 offen lds
  s_add_u32 m0, s39, 4096
  s_nop 0
  buffer_load_dwordx4 v22, s[8:11], s31 offen lds
  s_add_u32 m0, s39, 6144
  s_nop 0
  buffer_load_dwordx4 v23, s[8:11], s31 offen lds
  s_add_u32 m0, s39, 8192
  s_nop 0
  buffer_load_dwordx4 v24, s[8:11], s31 offen lds
  s_add_u32 m0, s39, 10240
  s_nop 0
  buffer_load_dwordx4 v25, s[8:11], s31 offen lds
  s_add_u32 m0, s39, 12288
  s_nop 0
  buffer_load_dwordx4 v26, s[8:11], s31 offen lds
  s_add_u32 m0, s39, 14336
  s_nop 0
  buffer_load_dwordx4 v27, s[8:11], s31 offen lds
  s_add_u32 s31, s31, 221184
  s_add_u32 s36, s36, 1
  s_cmp_eq_u32 s36, 5
  s_cselect_b32 s35, s77, 32768
  s_cselect_b32 s36, 0, s36
  s_add_u32 s33, s33, s35
  s_add_u32 s30, s30, 1
  s_cmp_lt_u32 s30, 5
  s_cbranch_scc1 L_p4_ll_82
  s_waitcnt vmcnt(16)
  s_barrier
  s_waitcnt vmcnt(8)
  s_barrier
  s_waitcnt vmcnt(0)
  s_barrier
  s_branch L_p4_ldT_81
L_p4_ldA_80:
  s_lshl_b32 s62, s75, 10
  s_lshl_b32 s39, s75, 10
  s_lshl_b32 s40, s28, 4
  s_add_u32 s39, s39, s40
  v_lshl_add_u32 v20, v1, 4, s39
  v_add_u32 v21, 0x8000, v20
  v_add_u32 v22, 0x10000, v20
  v_add_u32 v23, 0x18000, v20
  v_add_u32 v24, 0x20000, v20
  v_add_u32 v25, 0x28000, v20
  v_add_u32 v26, 0x30000, v20
  v_add_u32 v27, 0x38000, v20
  s_add_u32 s4, s60, 0xb00000
  s_addc_u32 s5, s61, 0
  s_and_b32 s5, s5, 0xffff
  s_mov_b32 s6, 0x280000
  s_mov_b32 s7, 0x20000
  s_mov_b32 s31, 0
  s_add_u32 s16, s60, 0x1a00000
  s_addc_u32 s17, s61, 0
  s_and_b32 s17, s17, 0xffff
  s_mov_b32 s18, 0x2000
  s_mov_b32 s19, 0x20000
  s_lshl_b32 s39, s21, 7
  s_add_u32 s39, s39, 4096
  v_lshl_add_u32 v4, v1, 3, s39
  s_mov_b32 exec_lo, 0xffff
  s_mov_b32 exec_hi, 0x0
  s_mov_b32 s86, 0
L_poll_84:
  buffer_load_dwordx2 v[12:13], v4, s[16:19], 0 offen sc1
  s_waitcnt vmcnt(0)
  v_xor_b32 v12, s90, v12
  v_xor_b32 v13, s91, v13
  v_or_b32 v12, v12, v13
  v_cmp_eq_u32 vcc, 0, v12
  s_add_u32 s86, s86, 1
  s_cmp_eq_u64 vcc, exec
  s_cbranch_scc1 L_pdone_85
  s_sleep 4
  s_cmp_lt_u32 s86, 0x40000
  s_cbranch_scc1 L_poll_84
L_pdone_85:
  s_mov_b64 exec, -1
L_pskip_83:
  s_add_u32 s39, s33, s62
  s_add_u32 m0, s39, 0
  s_nop 0
  buffer_load_dwordx4 v20, s[4:7], s31 offen sc1 lds
  s_add_u32 m0, s39, 2048
  s_nop 0
  buffer_load_dwordx4 v21, s[4:7], s31 offen sc1 lds
  s_add_u32 m0, s39, 4096
  s_nop 0
  buffer_load_dwordx4 v22, s[4:7], s31 offen sc1 lds
  s_add_u32 m0, s39, 6144
  s_nop 0
  buffer_load_dwordx4 v23, s[4:7], s31 offen sc1 lds
  s_add_u32 m0, s39, 8192
  s_nop 0
  buffer_load_dwordx4 v24, s[4:7], s31 offen sc1 lds
  s_add_u32 m0, s39, 10240
  s_nop 0
  buffer_load_dwordx4 v25, s[4:7], s31 offen sc1 lds
  s_add_u32 m0, s39, 12288
  s_nop 0
  buffer_load_dwordx4 v26, s[4:7], s31 offen sc1 lds
  s_add_u32 m0, s39, 14336
  s_nop 0
  buffer_load_dwordx4 v27, s[4:7], s31 offen sc1 lds
  s_add_u32 s31, s31, 262144
  s_add_u32 s36, s36, 1
  s_cmp_eq_u32 s36, 5
  s_cselect_b32 s35, s77, 32768
  s_cselect_b32 s36, 0, s36
  s_add_u32 s33, s33, s35
  s_add_u32 s39, s33, s62
  s_add_u32 m0, s39, 0
  s_nop 0
  buffer_load_dwordx4 v20, s[4:7], s31 offen sc1 lds
  s_add_u32 m0, s39, 2048
  s_nop 0
  buffer_load_dwordx4 v21, s[4:7], s31 offen sc1 lds
  s_add_u32 m0, s39, 4096
  s_nop 0
  buffer_load_dwordx4 v22, s[4:7], s31 offen sc1 lds
  s_add_u32 m0, s39, 6144
  s_nop 0
  buffer_load_dwordx4 v23, s[4:7], s31 offen sc1 lds
  s_add_u32 m0, s39, 8192
  s_nop 0
  buffer_load_dwordx4 v24, s[4:7], s31 offen sc1 lds
  s_add_u32 m0, s39, 10240
  s_nop 0
  buffer_load_dwordx4 v25, s[4:7], s31 offen sc1 lds
  s_add_u32 m0, s39, 12288
  s_nop 0
  buffer_load_dwordx4 v26, s[4:7], s31 offen sc1 lds
  s_add_u32 m0, s39, 14336
  s_nop 0
  buffer_load_dwordx4 v27, s[4:7], s31 offen sc1 lds
  s_add_u32 s31, s31, 262144
  s_add_u32 s36, s36, 1
  s_cmp_eq_u32 s36, 5
  s_cselect_b32 s35, s77, 32768
  s_cselect_b32 s36, 0, s36
  s_add_u32 s33, s33, s35
  s_waitcnt vmcnt(8)
  s_barrier
  s_add_u32 s39, s33, s62
  s_add_u32 m0, s39, 0
  s_nop 0
  buffer_load_dwordx4 v20, s[4:7], s31 offen sc1 lds
  s_add_u32 m0, s39, 2048
  s_nop 0
  buffer_load_dwordx4 v21, s[4:7], s31 offen sc1 lds
  s_add_u32 m0, s39, 4096
  s_nop 0
  buffer_load_dwordx4 v22, s[4:7], s31 offen sc1 lds
  s_add_u32 m0, s39, 6144
  s_nop 0
  buffer_load_dwordx4 v23, s[4:7], s31 offen sc1 lds
  s_add_u32 m0, s39, 8192
  s_nop 0
  buffer_load_dwordx4 v24, s[4:7], s31 offen sc1 lds
  s_add_u32 m0, s39, 10240
  s_nop 0
  buffer_load_dwordx4 v25, s[4:7], s31 offen sc1 lds
  s_add_u32 m0, s39, 12288
  s_nop 0
  buffer_load_dwordx4 v26, s[4:7], s31 offen sc1 lds
  s_add_u32 m0, s39, 14336
  s_nop 0
  buffer_load_dwordx4 v27, s[4:7], s31 offen sc1 lds
  s_add_u32 s31, s31, 262144
  s_add_u32 s36, s36, 1
  s_cmp_eq_u32 s36, 5
  s_cselect_b32 s35, s77, 32768
  s_cselect_b32 s36, 0, s36
  s_add_u32 s33, s33, s35
  s_add_u32 s39, s33, s62
  s_add_u32 m0, s39, 0
  s_nop 0
  buffer_load_dwordx4 v20, s[4:7], s31 offen sc1 lds
  s_add_u32 m0, s39, 2048
  s_nop 0
  buffer_load_dwordx4 v21, s[4:7], s31 offen sc1 lds
  s_add_u32 m0, s39, 4096
  s_nop 0
  buffer_load_dwordx4 v22, s[4:7], s31 offen sc1 lds
  s_add_u32 m0, s39, 6144
  s_nop 0
  buffer_load_dwordx4 v23, s[4:7], s31 offen sc1 lds
  s_add_u32 m0, s39, 8192
  s_nop 0
  buffer_load_dwordx4 v24, s[4:7], s31 offen sc1 lds
  s_add_u32 m0, s39, 10240
  s_nop 0
  buffer_load_dwordx4 v25, s[4:7], s31 offen sc1 lds
  s_add_u32 m0, s39, 12288
  s_nop 0
  buffer_load_dwordx4 v26, s[4:7], s31 offen sc1 lds
  s_add_u32 m0, s39, 14336
  s_nop 0
  buffer_load_dwordx4 v27, s[4:7], s31 offen sc1 lds
  s_add_u32 s31, s31, 262144
  s_add_u32 s36, s36, 1
  s_cmp_eq_u32 s36, 5
  s_cselect_b32 s35, s77, 32768
  s_cselect_b32 s36, 0, s36
  s_add_u32 s33, s33, s35
  s_mov_b32 s30, 0
L_p4_ll_86:
  s_waitcnt vmcnt(16)
  s_barrier
  s_add_u32 s39, s33, s62
  s_add_u32 m0, s39, 0
  s_nop 0
  buffer_load_dwordx4 v20, s[4:7], s31 offen sc1 lds
  s_add_u32 m0, s39, 2048
  s_nop 0
  buffer_load_dwordx4 v21, s[4:7], s31 offen sc1 lds
  s_add_u32 m0, s39, 4096
  s_nop 0
  buffer_load_dwordx4 v22, s[4:7], s31 offen sc1 lds
  s_add_u32 m0, s39, 6144
  s_nop 0
  buffer_load_dwordx4 v23, s[4:7], s31 offen sc1 lds
  s_add_u32 m0, s39, 8192
  s_nop 0
  buffer_load_dwordx4 v24, s[4:7], s31 offen sc1 lds
  s_add_u32 m0, s39, 10240
  s_nop 0
  buffer_load_dwordx4 v25, s[4:7], s31 offen sc1 lds
  s_add_u32 m0, s39, 12288
  s_nop 0
  buffer_load_dwordx4 v26, s[4:7], s31 offen sc1 lds
  s_add_u32 m0, s39, 14336
  s_nop 0
  buffer_load_dwordx4 v27, s[4:7], s31 offen sc1 lds
  s_add_u32 s31, s31, 262144
  s_add_u32 s36, s36, 1
  s_cmp_eq_u32 s36, 5
  s_cselect_b32 s35, s77, 32768
  s_cselect_b32 s36, 0, s36
  s_add_u32 s33, s33, s35
  s_add_u32 s30, s30, 1
  s_cmp_lt_u32 s30, 6
  s_cbranch_scc1 L_p4_ll_86
  s_waitcnt vmcnt(16)
  s_barrier
  s_waitcnt vmcnt(8)
  s_barrier
  s_waitcnt vmcnt(0)
  s_barrier
L_p4_ldT_81:
  s_add_u32 s16, s60, 0x1a10000
  s_addc_u32 s17, s61, 0
  s_and_b32 s17, s17, 0xffff
  s_mov_b32 s18, 0x20000
  s_mov_b32 s19, 0x20000
  s_lshl_b32 s39, s23, 5
  v_add_u32 v5, s39, v1
  v_add_u32 v4, s28, v5
  v_lshlrev_b32 v4, 6, v4
  s_mov_b32 exec_hi, 0
  buffer_load_dwordx4 v[36:39], v4, s[16:19], 0 offen offset:0 sc1
  buffer_load_dwordx4 v[40:43], v4, s[16:19], 0 offen offset:16 sc1
  buffer_load_dwordx4 v[44:47], v4, s[16:19], 0 offen offset:32 sc1
  buffer_load_dwordx4 v[48:51], v4, s[16:19], 0 offen offset:48 sc1
  v_lshlrev_b32 v5, 3, v5
  v_add_u32 v5, 65536, v5
  s_waitcnt vmcnt(0)
  v_pk_add_f32 v[36:37], v[36:37], v[38:39]
  v_pk_add_f32 v[36:37], v[36:37], v[40:41]
  v_pk_add_f32 v[36:37], v[36:37], v[42:43]
  v_pk_add_f32 v[36:37], v[36:37], v[44:45]
  v_pk_add_f32 v[36:37], v[36:37], v[46:47]
  v_pk_add_f32 v[36:37], v[36:37], v[48:49]
  v_pk_add_f32 v[36:37], v[36:37], v[50:51]
  ds_write_b64 v5, v[36:37]
  s_mov_b32 exec_hi, -1
  s_waitcnt lgkmcnt(0)
  s_barrier
  s_barrier
L_p4_join_77:
L_p5_75:
  s_lshl_b32 s28, s21, 7
  s_and_b32 s39, s22, 1
  s_lshl_b32 s39, s39, 6
  s_add_u32 s28, s28, s39
  s_lshr_b32 s38, s22, 1
  s_mul_i32 s29, s38, 80
  s_mov_b32 s77, -110592
  s_mov_b32 s36, 0
  s_mov_b32 s30, 0
  s_cmp_ge_u32 s20, 4
  s_cbranch_scc1 L_p5_ld_87
  s_lshr_b32 s74, s23, 1
  s_and_b32 s75, s23, 1
  v_mul_u32_u24 v28, 1024, v2
  v_lshl_add_u32 v28, v3, 4, v28
  s_mul_i32 s39, s74, 512
  v_add_u32 v28, s39, v28
  s_mul_i32 s39, s75, 4096
  v_add_u32 v28, s39, v28
  s_lshl_b32 s39, s75, 8
  v_sub_u32 v29, v28, s39
  v_add_u32 v29, 256, v29
  v_add_u32 v28, s39, v28
  v_lshrrev_b32 v4, 2, v3
  v_and_b32 v5, 3, v3
  v_lshl_add_u32 v4, v2, 2, v4
  v_mul_u32_u24 v4, 160, v4
  v_lshl_add_u32 v30, v5, 3, v4
  v_add_u32 v30, 8192, v30
  s_mul_i32 s39, s75, 5120
  v_add_u32 v30, s39, v30
  v_mov_b32 v32, 0
  v_mov_b32 v33, 0
  v_mov_b32 v34, 0
  v_mov_b32 v35, 0
  v_mov_b32 v36, 0
  v_mov_b32 v37, 0
  v_mov_b32 v38, 0
  v_mov_b32 v39, 0
  v_mov_b32 v40, 0
  v_mov_b32 v41, 0
  v_mov_b32 v42, 0
  v_mov_b32 v43, 0
  v_mov_b32 v44, 0
  v_mov_b32 v45, 0
  v_mov_b32 v46, 0
  v_mov_b32 v47, 0
  v_mov_b32 v48, 0
  v_mov_b32 v49, 0
  v_mov_b32 v50, 0
  v_mov_b32 v51, 0
  v_mov_b32 v52, 0
  v_mov_b32 v53, 0
  v_mov_b32 v54, 0
  v_mov_b32 v55, 0
  v_mov_b32 v56, 0
  v_mov_b32 v57, 0
  v_mov_b32 v58, 0
  v_mov_b32 v59, 0
  v_mov_b32 v60, 0
  v_mov_b32 v61, 0
  v_mov_b32 v62, 0
  v_mov_b32 v63, 0
  v_mov_b32 v64, 0
  v_mov_b32 v65, 0
  v_mov_b32 v66, 0
  v_mov_b32 v67, 0
  v_mov_b32 v68, 0
  v_mov_b32 v69, 0
  v_mov_b32 v70, 0
  v_mov_b32 v71, 0
  s_mov_b32 s12, s56
  s_and_b32 s13, s57, 0xffff
  s_mov_b32 s14, 0x280000
  s_mov_b32 s15, 0x20000
  s_add_u32 s16, s60, 0xb00000
  s_addc_u32 s17, s61, 0
  s_and_b32 s17, s17, 0xffff
  s_mov_b32 s18, 0x280000
  s_mov_b32 s19, 0x20000
  s_lshl_b32 s39, s23, 4
  s_add_u32 s39, s39, s28
  v_add_u32 v4, s39, v3
  v_lshlrev_b32 v4, 4, v4
  v_lshrrev_b32 v5, 1, v2
  v_mul_u32_u24 v5, 32768, v5
  v_add_u32 v4, v4, v5
  v_and_b32 v5, 1, v2
  v_lshl_add_u32 v4, v5, 3, v4
  s_lshr_b32 s39, s29, 3
  s_mul_i32 s39, s39, 32768
  buffer_load_dwordx2 v[128:129], v4, s[16:19], s39 offen sc1
  s_add_u32 s39, s39, 65536
  buffer_load_dwordx2 v[130:131], v4, s[16:19], s39 offen sc1
  s_add_u32 s39, s39, 65536
  buffer_load_dwordx2 v[132:133], v4, s[16:19], s39 offen sc1
  s_add_u32 s39, s39, 65536
  buffer_load_dwordx2 v[134:135], v4, s[16:19], s39 offen sc1
  s_add_u32 s39, s39, 65536
  buffer_load_dwordx2 v[136:137], v4, s[16:19], s39 offen sc1
  s_barrier
  ds_read_b64_tr_b16 v[88:89], v30 offset:0
  ds_read_b64_tr_b16 v[90:91], v30 offset:2560
  ds_read_b64_tr_b16 v[92:93], v30 offset:32
  ds_read_b64_tr_b16 v[94:95], v30 offset:2592
  ds_read_b64_tr_b16 v[96:97], v30 offset:64
  ds_read_b64_tr_b16 v[98:99], v30 offset:2624
  ds_read_b64_tr_b16 v[100:101], v30 offset:96
  ds_read_b64_tr_b16 v[102:103], v30 offset:2656
  ds_read_b64_tr_b16 v[104:105], v30 offset:128
  ds_read_b64_tr_b16 v[106:107], v30 offset:2688
  ds_read_b128 v[72:75], v28 offset:0
  ds_read_b128 v[76:79], v29 offset:0
L_p5_loop_89:
  s_barrier
  s_add_u32 s36, s36, 1
  s_cmp_eq_u32 s36, 7
  s_cselect_b32 s35, s77, 18432
  s_cselect_b32 s36, 0, s36
  v_add_u32 v28, s35, v28
  v_add_u32 v29, s35, v29
  v_add_u32 v30, s35, v30
  s_waitcnt lgkmcnt(0)
  ds_read_b64_tr_b16 v[108:109], v30 offset:0
  ds_read_b64_tr_b16 v[110:111], v30 offset:2560
  v_mfma_f32_16x16x32_bf16 v[32:35], v[88:91], v[72:75], v[32:35]
  ds_read_b64_tr_b16 v[112:113], v30 offset:32
  ds_read_b64_tr_b16 v[114:115], v30 offset:2592
  v_mfma_f32_16x16x32_bf16 v[36:39], v[92:95], v[72:75], v[36:39]
  ds_read_b64_tr_b16 v[116:117], v30 offset:64
  ds_read_b64_tr_b16 v[118:119], v30 offset:2624
  v_mfma_f32_16x16x32_bf16 v[40:43], v[96:99], v[72:75], v[40:43]
  ds_read_b64_tr_b16 v[120:121], v30 offset:96
  ds_read_b64_tr_b16 v[122:123], v30 offset:2656
  v_mfma_f32_16x16x32_bf16 v[44:47], v[100:103], v[72:75], v[44:47]
  ds_read_b64_tr_b16 v[124:125], v30 offset:128
  ds_read_b64_tr_b16 v[126:127], v30 offset:2688
  v_mfma_f32_16x16x32_bf16 v[48:51], v[104:107], v[72:75], v[48:51]
  ds_read_b128 v[80:83], v28 offset:0
  ds_read_b128 v[84:87], v29 offset:0
  v_mfma_f32_16x16x32_bf16 v[52:55], v[88:91], v[76:79], v[52:55]
  v_mfma_f32_16x16x32_bf16 v[56:59], v[92:95], v[76:79], v[56:59]
  v_mfma_f32_16x16x32_bf16 v[60:63], v[96:99], v[76:79], v[60:63]
  v_mfma_f32_16x16x32_bf16 v[64:67], v[100:103], v[76:79], v[64:67]
  v_mfma_f32_16x16x32_bf16 v[68:71], v[104:107], v[76:79], v[68:71]
  s_barrier
  s_add_u32 s36, s36, 1
  s_cmp_eq_u32 s36, 7
  s_cselect_b32 s35, s77, 18432
  s_cselect_b32 s36, 0, s36
  v_add_u32 v28, s35, v28
  v_add_u32 v29, s35, v29
  v_add_u32 v30, s35, v30
  s_waitcnt lgkmcnt(0)
  ds_read_b64_tr_b16 v[88:89], v30 offset:0
  ds_read_b64_tr_b16 v[90:91], v30 offset:2560
  v_mfma_f32_16x16x32_bf16 v[32:35], v[108:111], v[80:83], v[32:35]
  ds_read_b64_tr_b16 v[92:93], v30 offset:32
  ds_read_b64_tr_b16 v[94:95], v30 offset:2592
  v_mfma_f32_16x16x32_bf16 v[36:39], v[112:115], v[80:83], v[36:39]
  ds_read_b64_tr_b16 v[96:97], v30 offset:64
  ds_read_b64_tr_b16 v[98:99], v30 offset:2624
  v_mfma_f32_16x16x32_bf16 v[40:43], v[116:119], v[80:83], v[40:43]
  ds_read_b64_tr_b16 v[100:101], v30 offset:96
  ds_read_b64_tr_b16 v[102:103], v30 offset:2656
  v_mfma_f32_16x16x32_bf16 v[44:47], v[120:123], v[80:83], v[44:47]
  ds_read_b64_tr_b16 v[104:105], v30 offset:128
  ds_read_b64_tr_b16 v[106:107], v30 offset:2688
  v_mfma_f32_16x16x32_bf16 v[48:51], v[124:127], v[80:83], v[48:51]
  ds_read_b128 v[72:75], v28 offset:0
  ds_read_b128 v[76:79], v29 offset:0
  v_mfma_f32_16x16x32_bf16 v[52:55], v[108:111], v[84:87], v[52:55]
  v_mfma_f32_16x16x32_bf16 v[56:59], v[112:115], v[84:87], v[56:59]
  v_mfma_f32_16x16x32_bf16 v[60:63], v[116:119], v[84:87], v[60:63]
  v_mfma_f32_16x16x32_bf16 v[64:67], v[120:123], v[84:87], v[64:67]
  v_mfma_f32_16x16x32_bf16 v[68:71], v[124:127], v[84:87], v[68:71]
  s_add_u32 s30, s30, 1
  s_cmp_lt_u32 s30, 13
  s_cbranch_scc1 L_p5_loop_89
  s_waitcnt lgkmcnt(0)
  v_mfma_f32_16x16x32_bf16 v[32:35], v[88:91], v[72:75], v[32:35]
  v_mfma_f32_16x16x32_bf16 v[36:39], v[92:95], v[72:75], v[36:39]
  v_mfma_f32_16x16x32_bf16 v[40:43], v[96:99], v[72:75], v[40:43]
  v_mfma_f32_16x16x32_bf16 v[44:47], v[100:103], v[72:75], v[44:47]
  v_mfma_f32_16x16x32_bf16 v[48:51], v[104:107], v[72:75], v[48:51]
  v_mfma_f32_16x16x32_bf16 v[52:55], v[88:91], v[76:79], v[52:55]
  v_mfma_f32_16x16x32_bf16 v[56:59], v[92:95], v[76:79], v[56:59]
  v_mfma_f32_16x16x32_bf16 v[60:63], v[96:99], v[76:79], v[60:63]
  v_mfma_f32_16x16x32_bf16 v[64:67], v[100:103], v[76:79], v[64:67]
  v_mfma_f32_16x16x32_bf16 v[68:71], v[104:107], v[76:79], v[68:71]
  s_nop 7
  s_mul_i32 s39, s23, 5120
  s_add_u32 s39, s39, 131072
  v_lshl_add_u32 v4, v1, 4, s39
  ds_write_b128 v4, v[52:55] offset:0
  ds_write_b128 v4, v[56:59] offset:1024
  ds_write_b128 v4, v[60:63] offset:2048
  ds_write_b128 v4, v[64:67] offset:3072
  ds_write_b128 v4, v[68:71] offset:4096
  s_xor_b32 s39, s23, 1
  s_mul_i32 s39, s39, 5120
  s_add_u32 s39, s39, 131072
  v_lshl_add_u32 v4, v1, 4, s39
  s_waitcnt lgkmcnt(0)
  s_barrier
  ds_read_b128 v[52:55], v4 offset:0
  ds_read_b128 v[56:59], v4 offset:1024
  ds_read_b128 v[60:63], v4 offset:2048
  ds_read_b128 v[64:67], v4 offset:3072
  ds_read_b128 v[68:71], v4 offset:4096
  s_lshl_b32 s39, s23, 4
  s_add_u32 s39, s39, s28
  v_add_u32 v4, s39, v3
  v_mul_u32_u24 v4, 1280, v4
  v_and_b32 v5, 1, v2
  v_lshl_add_u32 v138, v5, 5, v4
  v_lshrrev_b32 v6, 1, v2
  v_lshl_add_u32 v138, v6, 4, v138
  v_lshl_add_u32 v6, v2, 3, v4
  s_lshl_b32 s70, s29, 1
  s_add_u32 s71, s70, 64
  s_add_u32 s72, s70, 128
  s_waitcnt vmcnt(0) lgkmcnt(0)
  v_pk_add_f32 v[32:33], v[32:33], v[52:53]
  v_pk_add_f32 v[34:35], v[34:35], v[54:55]
  v_lshlrev_b32 v4, 16, v128
  v_and_b32 v5, 0xffff0000, v128
  v_add_f32 v32, v32, v4
  v_add_f32 v33, v33, v5
  v_lshlrev_b32 v4, 16, v129
  v_and_b32 v5, 0xffff0000, v129
  v_add_f32 v34, v34, v4
  v_add_f32 v35, v35, v5
  v_cvt_pk_bf16_f32 v140, v32, v33
  v_cvt_pk_bf16_f32 v141, v34, v35
  v_pk_add_f32 v[36:37], v[36:37], v[56:57]
  v_pk_add_f32 v[38:39], v[38:39], v[58:59]
  v_lshlrev_b32 v4, 16, v130
  v_and_b32 v5, 0xffff0000, v130
  v_add_f32 v36, v36, v4
  v_add_f32 v37, v37, v5
  v_lshlrev_b32 v4, 16, v131
  v_and_b32 v5, 0xffff0000, v131
  v_add_f32 v38, v38, v4
  v_add_f32 v39, v39, v5
  v_cvt_pk_bf16_f32 v142, v36, v37
  v_cvt_pk_bf16_f32 v143, v38, v39
  s_nop 1
  v_permlane16_swap_b32 v140, v142
  v_permlane16_swap_b32 v141, v143
  buffer_store_dwordx4 v[140:143], v138, s[12:15], s70 offen
  v_pk_add_f32 v[40:41], v[40:41], v[60:61]
  v_pk_add_f32 v[42:43], v[42:43], v[62:63]
  v_lshlrev_b32 v4, 16, v132
  v_and_b32 v5, 0xffff0000, v132
  v_add_f32 v40, v40, v4
  v_add_f32 v41, v41, v5
  v_lshlrev_b32 v4, 16, v133
  v_and_b32 v5, 0xffff0000, v133
  v_add_f32 v42, v42, v4
  v_add_f32 v43, v43, v5
  v_cvt_pk_bf16_f32 v144, v40, v41
  v_cvt_pk_bf16_f32 v145, v42, v43
  v_pk_add_f32 v[44:45], v[44:45], v[64:65]
  v_pk_add_f32 v[46:47], v[46:47], v[66:67]
  v_lshlrev_b32 v4, 16, v134
  v_and_b32 v5, 0xffff0000, v134
  v_add_f32 v44, v44, v4
  v_add_f32 v45, v45, v5
  v_lshlrev_b32 v4, 16, v135
  v_and_b32 v5, 0xffff0000, v135
  v_add_f32 v46, v46, v4
  v_add_f32 v47, v47, v5
  v_cvt_pk_bf16_f32 v146, v44, v45
  v_cvt_pk_bf16_f32 v147, v46, v47
  s_nop 1
  v_permlane16_swap_b32 v144, v146
  v_permlane16_swap_b32 v145, v147
  buffer_store_dwordx4 v[144:147], v138, s[12:15], s71 offen
  v_pk_add_f32 v[48:49], v[48:49], v[68:69]
  v_pk_add_f32 v[50:51], v[50:51], v[70:71]
  v_lshlrev_b32 v4, 16, v136
  v_and_b32 v5, 0xffff0000, v136
  v_add_f32 v48, v48, v4
  v_add_f32 v49, v49, v5
  v_lshlrev_b32 v4, 16, v137
  v_and_b32 v5, 0xffff0000, v137
  v_add_f32 v50, v50, v4
  v_add_f32 v51, v51, v5
  v_cvt_pk_bf16_f32 v140, v48, v49
  v_cvt_pk_bf16_f32 v141, v50, v51
  buffer_store_dwordx2 v[140:141], v6, s[12:15], s72 offen
  s_branch L_p5_join_88
L_p5_ld_87:
  s_and_b32 s75, s23, 1
  s_mov_b32 s33, 0
  s_cmp_ge_u32 s23, 2
  s_cbranch_scc1 L_p5_ldA_90
  s_lshl_b32 s62, s75, 10
  s_add_u32 s62, s62, 8192
  s_lshl_b32 s39, s75, 10
  v_lshl_add_u32 v20, v1, 4, s39
  v_add_u32 v21, 2048, v20
  v_add_u32 v22, 4096, v20
  v_add_u32 v23, 6144, v20
  v_add_u32 v24, 8192, v20
  s_add_u32 s8, s60, 0x16c8000
  s_addc_u32 s9, s61, 0
  s_and_b32 s9, s9, 0xffff
  s_mov_b32 s10, 0x21c000
  s_mov_b32 s11, 0x20000
  s_mul_i32 s31, s38, 276480
  s_add_u32 s16, s60, 0x1a00000
  s_addc_u32 s17, s61, 0
  s_and_b32 s17, s17, 0xffff
  s_mov_b32 s18, 0x2000
  s_mov_b32 s19, 0x20000
  v_lshlrev_b32 v4, 4, v1
  v_add_u32 v4, 2048, v4
  s_mov_b32 s86, 0
L_poll_93:
  buffer_load_dwordx4 v[12:15], v4, s[16:19], 0 offen sc1
  buffer_load_dwordx4 v[16:19], v4, s[16:19], 0 offen offset:1024 sc1
  s_waitcnt vmcnt(0)
  v_xor_b32 v12, s90, v12
  v_xor_b32 v13, s91, v13
  v_xor_b32 v14, s90, v14
  v_xor_b32 v15, s91, v15
  v_xor_b32 v16, s90, v16
  v_xor_b32 v17, s91, v17
  v_xor_b32 v18, s90, v18
  v_xor_b32 v19, s91, v19
  v_or3_b32 v12, v12, v13, v14
  v_or3_b32 v15, v15, v16, v17
  v_or3_b32 v12, v12, v18, v19
  v_or_b32 v12, v12, v15
  v_cmp_eq_u32 vcc, 0, v12
  s_add_u32 s86, s86, 1
  s_cmp_eq_u64 vcc, exec
  s_cbranch_scc1 L_pdone_94
  s_sleep 1
  s_cmp_lt_u32 s86, 0x40000
  s_cbranch_scc1 L_poll_93
L_pdone_94:
  s_mov_b64 exec, -1
L_pskip_92:
  s_add_u32 s39, s33, s62
  s_add_u32 m0, s39, 0
  s_nop 0
  buffer_load_dwordx4 v20, s[8:11], s31 offen sc1 lds
  s_add_u32 m0, s39, 2048
  s_nop 0
  buffer_load_dwordx4 v21, s[8:11], s31 offen sc1 lds
  s_add_u32 m0, s39, 4096
  s_nop 0
  buffer_load_dwordx4 v22, s[8:11], s31 offen sc1 lds
  s_add_u32 m0, s39, 6144
  s_nop 0
  buffer_load_dwordx4 v23, s[8:11], s31 offen sc1 lds
  s_add_u32 m0, s39, 8192
  s_nop 0
  buffer_load_dwordx4 v24, s[8:11], s31 offen sc1 lds
  s_add_u32 s31, s31, 10240
  s_add_u32 s36, s36, 1
  s_cmp_eq_u32 s36, 7
  s_cselect_b32 s35, s77, 18432
  s_cselect_b32 s36, 0, s36
  s_add_u32 s33, s33, s35
  s_add_u32 s39, s33, s62
  s_add_u32 m0, s39, 0
  s_nop 0
  buffer_load_dwordx4 v20, s[8:11], s31 offen sc1 lds
  s_add_u32 m0, s39, 2048
  s_nop 0
  buffer_load_dwordx4 v21, s[8:11], s31 offen sc1 lds
  s_add_u32 m0, s39, 4096
  s_nop 0
  buffer_load_dwordx4 v22, s[8:11], s31 offen sc1 lds
  s_add_u32 m0, s39, 6144
  s_nop 0
  buffer_load_dwordx4 v23, s[8:11], s31 offen sc1 lds
  s_add_u32 m0, s39, 8192
  s_nop 0
  buffer_load_dwordx4 v24, s[8:11], s31 offen sc1 lds
  s_add_u32 s31, s31, 10240
  s_add_u32 s36, s36, 1
  s_cmp_eq_u32 s36, 7
  s_cselect_b32 s35, s77, 18432
  s_cselect_b32 s36, 0, s36
  s_add_u32 s33, s33, s35
  s_add_u32 s39, s33, s62
  s_add_u32 m0, s39, 0
  s_nop 0
  buffer_load_dwordx4 v20, s[8:11], s31 offen sc1 lds
  s_add_u32 m0, s39, 2048
  s_nop 0
  buffer_load_dwordx4 v21, s[8:11], s31 offen sc1 lds
  s_add_u32 m0, s39, 4096
  s_nop 0
  buffer_load_dwordx4 v22, s[8:11], s31 offen sc1 lds
  s_add_u32 m0, s39, 6144
  s_nop 0
  buffer_load_dwordx4 v23, s[8:11], s31 offen sc1 lds
  s_add_u32 m0, s39, 8192
  s_nop 0
  buffer_load_dwordx4 v24, s[8:11], s31 offen sc1 lds
  s_add_u32 s31, s31, 10240
  s_add_u32 s36, s36, 1
  s_cmp_eq_u32 s36, 7
  s_cselect_b32 s35, s77, 18432
  s_cselect_b32 s36, 0, s36
  s_add_u32 s33, s33, s35
  s_add_u32 s39, s33, s62
  s_add_u32 m0, s39, 0
  s_nop 0
  buffer_load_dwordx4 v20, s[8:11], s31 offen sc1 lds
  s_add_u32 m0, s39, 2048
  s_nop 0
  buffer_load_dwordx4 v21, s[8:11], s31 offen sc1 lds
  s_add_u32 m0, s39, 4096
  s_nop 0
  buffer_load_dwordx4 v22, s[8:11], s31 offen sc1 lds
  s_add_u32 m0, s39, 6144
  s_nop 0
  buffer_load_dwordx4 v23, s[8:11], s31 offen sc1 lds
  s_add_u32 m0, s39, 8192
  s_nop 0
  buffer_load_dwordx4 v24, s[8:11], s31 offen sc1 lds
  s_add_u32 s31, s31, 10240
  s_add_u32 s36, s36, 1
  s_cmp_eq_u32 s36, 7
  s_cselect_b32 s35, s77, 18432
  s_cselect_b32 s36, 0, s36
  s_add_u32 s33, s33, s35
  s_add_u32 s39, s33, s62
  s_add_u32 m0, s39, 0
  s_nop 0
  buffer_load_dwordx4 v20, s[8:11], s31 offen sc1 lds
  s_add_u32 m0, s39, 2048
  s_nop 0
  buffer_load_dwordx4 v21, s[8:11], s31 offen sc1 lds
  s_add_u32 m0, s39, 4096
  s_nop 0
  buffer_load_dwordx4 v22, s[8:11], s31 offen sc1 lds
  s_add_u32 m0, s39, 6144
  s_nop 0
  buffer_load_dwordx4 v23, s[8:11], s31 offen sc1 lds
  s_add_u32 m0, s39, 8192
  s_nop 0
  buffer_load_dwordx4 v24, s[8:11], s31 offen sc1 lds
  s_add_u32 s31, s31, 10240
  s_add_u32 s36, s36, 1
  s_cmp_eq_u32 s36, 7
  s_cselect_b32 s35, s77, 18432
  s_cselect_b32 s36, 0, s36
  s_add_u32 s33, s33, s35
  s_add_u32 s39, s33, s62
  s_add_u32 m0, s39, 0
  s_nop 0
  buffer_load_dwordx4 v20, s[8:11], s31 offen sc1 lds
  s_add_u32 m0, s39, 2048
  s_nop 0
  buffer_load_dwordx4 v21, s[8:11], s31 offen sc1 lds
  s_add_u32 m0, s39, 4096
  s_nop 0
  buffer_load_dwordx4 v22, s[8:11], s31 offen sc1 lds
  s_add_u32 m0, s39, 6144
  s_nop 0
  buffer_load_dwordx4 v23, s[8:11], s31 offen sc1 lds
  s_add_u32 m0, s39, 8192
  s_nop 0
  buffer_load_dwordx4 v24, s[8:11], s31 offen sc1 lds
  s_add_u32 s31, s31, 10240
  s_add_u32 s36, s36, 1
  s_cmp_eq_u32 s36, 7
  s_cselect_b32 s35, s77, 18432
  s_cselect_b32 s36, 0, s36
  s_add_u32 s33, s33, s35
  s_add_u32 s39, s33, s62
  s_add_u32 m0, s39, 0
  s_nop 0
  buffer_load_dwordx4 v20, s[8:11], s31 offen sc1 lds
  s_add_u32 m0, s39, 2048
  s_nop 0
  buffer_load_dwordx4 v21, s[8:11], s31 offen sc1 lds
  s_add_u32 m0, s39, 4096
  s_nop 0
  buffer_load_dwordx4 v22, s[8:11], s31 offen sc1 lds
  s_add_u32 m0, s39, 6144
  s_nop 0
  buffer_load_dwordx4 v23, s[8:11], s31 offen sc1 lds
  s_add_u32 m0, s39, 8192
  s_nop 0
  buffer_load_dwordx4 v24, s[8:11], s31 offen sc1 lds
  s_add_u32 s31, s31, 10240
  s_add_u32 s36, s36, 1
  s_cmp_eq_u32 s36, 7
  s_cselect_b32 s35, s77, 18432
  s_cselect_b32 s36, 0, s36
  s_add_u32 s33, s33, s35
  s_waitcnt vmcnt(30)
  s_barrier
  s_waitcnt vmcnt(25)
  s_barrier
  s_mov_b32 s30, 0
L_p5_ll_95:
  s_waitcnt vmcnt(20)
  s_barrier
  s_add_u32 s39, s33, s62
  s_add_u32 m0, s39, 0
  s_nop 0
  buffer_load_dwordx4 v20, s[8:11], s31 offen sc1 lds
  s_add_u32 m0, s39, 2048
  s_nop 0
  buffer_load_dwordx4 v21, s[8:11], s31 offen sc1 lds
  s_add_u32 m0, s39, 4096
  s_nop 0
  buffer_load_dwordx4 v22, s[8:11], s31 offen sc1 lds
  s_add_u32 m0, s39, 6144
  s_nop 0
  buffer_load_dwordx4 v23, s[8:11], s31 offen sc1 lds
  s_add_u32 m0, s39, 8192
  s_nop 0
  buffer_load_dwordx4 v24, s[8:11], s31 offen sc1 lds
  s_add_u32 s31, s31, 10240
  s_add_u32 s36, s36, 1
  s_cmp_eq_u32 s36, 7
  s_cselect_b32 s35, s77, 18432
  s_cselect_b32 s36, 0, s36
  s_add_u32 s33, s33, s35
  s_add_u32 s30, s30, 1
  s_cmp_lt_u32 s30, 20
  s_cbranch_scc1 L_p5_ll_95
  s_waitcnt vmcnt(20)
  s_barrier
  s_waitcnt vmcnt(15)
  s_barrier
  s_waitcnt vmcnt(10)
  s_barrier
  s_waitcnt vmcnt(5)
  s_barrier
  s_waitcnt vmcnt(0)
  s_barrier
  s_branch L_p5_ldT_91
L_p5_ldA_90:
  s_lshl_b32 s62, s75, 10
  s_mul_i32 s39, s75, 32768
  s_lshl_b32 s40, s28, 4
  s_add_u32 s39, s39, s40
  v_lshl_add_u32 v20, v1, 4, s39
  v_add_u32 v21, 0x10000, v20
  v_add_u32 v22, 0x20000, v20
  v_add_u32 v23, 0x30000, v20
  s_add_u32 s4, s60, 0xe00000
  s_addc_u32 s5, s61, 0
  s_and_b32 s5, s5, 0xffff
  s_mov_b32 s6, 0x6c0000
  s_mov_b32 s7, 0x20000
  s_mov_b32 s31, 0
  s_add_u32 s16, s60, 0x1a00000
  s_addc_u32 s17, s61, 0
  s_and_b32 s17, s17, 0xffff
  s_mov_b32 s18, 0x2000
  s_mov_b32 s19, 0x20000
  s_lshl_b32 s39, s21, 7
  s_add_u32 s39, s39, 6144
  v_lshl_add_u32 v4, v1, 3, s39
  s_mov_b32 exec_lo, 0x3fff
  s_mov_b32 exec_hi, 0x0
  s_mov_b32 s86, 0
L_poll_97:
  buffer_load_dwordx2 v[12:13], v4, s[16:19], 0 offen sc1
  s_waitcnt vmcnt(0)
  v_xor_b32 v12, s90, v12
  v_xor_b32 v13, s91, v13
  v_or_b32 v12, v12, v13
  v_cmp_eq_u32 vcc, 0, v12
  s_add_u32 s86, s86, 1
  s_cmp_eq_u64 vcc, exec
  s_cbranch_scc1 L_pdone_98
  s_sleep 4
  s_cmp_lt_u32 s86, 0x40000
  s_cbranch_scc1 L_poll_97
L_pdone_98:
  s_mov_b64 exec, -1
L_pskip_96:
  s_add_u32 s39, s33, s62
  s_add_u32 m0, s39, 0
  s_nop 0
  buffer_load_dwordx4 v20, s[4:7], s31 offen sc1 lds
  s_add_u32 m0, s39, 2048
  s_nop 0
  buffer_load_dwordx4 v21, s[4:7], s31 offen sc1 lds
  s_add_u32 m0, s39, 4096
  s_nop 0
  buffer_load_dwordx4 v22, s[4:7], s31 offen sc1 lds
  s_add_u32 m0, s39, 6144
  s_nop 0
  buffer_load_dwordx4 v23, s[4:7], s31 offen sc1 lds
  s_add_u32 s31, s31, 262144
  s_add_u32 s36, s36, 1
  s_cmp_eq_u32 s36, 7
  s_cselect_b32 s35, s77, 18432
  s_cselect_b32 s36, 0, s36
  s_add_u32 s33, s33, s35
  s_add_u32 s39, s33, s62
  s_add_u32 m0, s39, 0
  s_nop 0
  buffer_load_dwordx4 v20, s[4:7], s31 offen sc1 lds
  s_add_u32 m0, s39, 2048
  s_nop 0
  buffer_load_dwordx4 v21, s[4:7], s31 offen sc1 lds
  s_add_u32 m0, s39, 4096
  s_nop 0
  buffer_load_dwordx4 v22, s[4:7], s31 offen sc1 lds
  s_add_u32 m0, s39, 6144
  s_nop 0
  buffer_load_dwordx4 v23, s[4:7], s31 offen sc1 lds
  s_add_u32 s31, s31, 262144
  s_add_u32 s36, s36, 1
  s_cmp_eq_u32 s36, 7
  s_cselect_b32 s35, s77, 18432
  s_cselect_b32 s36, 0, s36
  s_add_u32 s33, s33, s35
  s_waitcnt vmcnt(4)
  s_barrier
  s_add_u32 s39, s33, s62
  s_add_u32 m0, s39, 0
  s_nop 0
  buffer_load_dwordx4 v20, s[4:7], s31 offen sc1 lds
  s_add_u32 m0, s39, 2048
  s_nop 0
  buffer_load_dwordx4 v21, s[4:7], s31 offen sc1 lds
  s_add_u32 m0, s39, 4096
  s_nop 0
  buffer_load_dwordx4 v22, s[4:7], s31 offen sc1 lds
  s_add_u32 m0, s39, 6144
  s_nop 0
  buffer_load_dwordx4 v23, s[4:7], s31 offen sc1 lds
  s_add_u32 s31, s31, 262144
  s_add_u32 s36, s36, 1
  s_cmp_eq_u32 s36, 7
  s_cselect_b32 s35, s77, 18432
  s_cselect_b32 s36, 0, s36
  s_add_u32 s33, s33, s35
  s_add_u32 s39, s33, s62
  s_add_u32 m0, s39, 0
  s_nop 0
  buffer_load_dwordx4 v20, s[4:7], s31 offen sc1 lds
  s_add_u32 m0, s39, 2048
  s_nop 0
  buffer_load_dwordx4 v21, s[4:7], s31 offen sc1 lds
  s_add_u32 m0, s39, 4096
  s_nop 0
  buffer_load_dwordx4 v22, s[4:7], s31 offen sc1 lds
  s_add_u32 m0, s39, 6144
  s_nop 0
  buffer_load_dwordx4 v23, s[4:7], s31 offen sc1 lds
  s_add_u32 s31, s31, 262144
  s_add_u32 s36, s36, 1
  s_cmp_eq_u32 s36, 7
  s_cselect_b32 s35, s77, 18432
  s_cselect_b32 s36, 0, s36
  s_add_u32 s33, s33, s35
  s_waitcnt vmcnt(8)
  s_barrier
  s_add_u32 s39, s33, s62
  s_add_u32 m0, s39, 0
  s_nop 0
  buffer_load_dwordx4 v20, s[4:7], s31 offen sc1 lds
  s_add_u32 m0, s39, 2048
  s_nop 0
  buffer_load_dwordx4 v21, s[4:7], s31 offen sc1 lds
  s_add_u32 m0, s39, 4096
  s_nop 0
  buffer_load_dwordx4 v22, s[4:7], s31 offen sc1 lds
  s_add_u32 m0, s39, 6144
  s_nop 0
  buffer_load_dwordx4 v23, s[4:7], s31 offen sc1 lds
  s_add_u32 s31, s31, 262144
  s_add_u32 s36, s36, 1
  s_cmp_eq_u32 s36, 7
  s_cselect_b32 s35, s77, 18432
  s_cselect_b32 s36, 0, s36
  s_add_u32 s33, s33, s35
  s_add_u32 s39, s33, s62
  s_add_u32 m0, s39, 0
  s_nop 0
  buffer_load_dwordx4 v20, s[4:7], s31 offen sc1 lds
  s_add_u32 m0, s39, 2048
  s_nop 0
  buffer_load_dwordx4 v21, s[4:7], s31 offen sc1 lds
  s_add_u32 m0, s39, 4096
  s_nop 0
  buffer_load_dwordx4 v22, s[4:7], s31 offen sc1 lds
  s_add_u32 m0, s39, 6144
  s_nop 0
  buffer_load_dwordx4 v23, s[4:7], s31 offen sc1 lds
  s_add_u32 s31, s31, 262144
  s_add_u32 s36, s36, 1
  s_cmp_eq_u32 s36, 7
  s_cselect_b32 s35, s77, 18432
  s_cselect_b32 s36, 0, s36
  s_add_u32 s33, s33, s35
  s_waitcnt vmcnt(12)
  s_barrier
  s_add_u32 s39, s33, s62
  s_add_u32 m0, s39, 0
  s_nop 0
  buffer_load_dwordx4 v20, s[4:7], s31 offen sc1 lds
  s_add_u32 m0, s39, 2048
  s_nop 0
  buffer_load_dwordx4 v21, s[4:7], s31 offen sc1 lds
  s_add_u32 m0, s39, 4096
  s_nop 0
  buffer_load_dwordx4 v22, s[4:7], s31 offen sc1 lds
  s_add_u32 m0, s39, 6144
  s_nop 0
  buffer_load_dwordx4 v23, s[4:7], s31 offen sc1 lds
  s_add_u32 s31, s31, 262144
  s_add_u32 s36, s36, 1
  s_cmp_eq_u32 s36, 7
  s_cselect_b32 s35, s77, 18432
  s_cselect_b32 s36, 0, s36
  s_add_u32 s33, s33, s35
  s_add_u32 s39, s33, s62
  s_add_u32 m0, s39, 0
  s_nop 0
  buffer_load_dwordx4 v20, s[4:7], s31 offen sc1 lds
  s_add_u32 m0, s39, 2048
  s_nop 0
  buffer_load_dwordx4 v21, s[4:7], s31 offen sc1 lds
  s_add_u32 m0, s39, 4096
  s_nop 0
  buffer_load_dwordx4 v22, s[4:7], s31 offen sc1 lds
  s_add_u32 m0, s39, 6144
  s_nop 0
  buffer_load_dwordx4 v23, s[4:7], s31 offen sc1 lds
  s_add_u32 s31, s31, 262144
  s_add_u32 s36, s36, 1
  s_cmp_eq_u32 s36, 7
  s_cselect_b32 s35, s77, 18432
  s_cselect_b32 s36, 0, s36
  s_add_u32 s33, s33, s35
  s_mov_b32 s30, 0
L_p5_ll_99:
  s_waitcnt vmcnt(16)
  s_barrier
  s_add_u32 s39, s33, s62
  s_add_u32 m0, s39, 0
  s_nop 0
  buffer_load_dwordx4 v20, s[4:7], s31 offen sc1 lds
  s_add_u32 m0, s39, 2048
  s_nop 0
  buffer_load_dwordx4 v21, s[4:7], s31 offen sc1 lds
  s_add_u32 m0, s39, 4096
  s_nop 0
  buffer_load_dwordx4 v22, s[4:7], s31 offen sc1 lds
  s_add_u32 m0, s39, 6144
  s_nop 0
  buffer_load_dwordx4 v23, s[4:7], s31 offen sc1 lds
  s_add_u32 s31, s31, 262144
  s_add_u32 s36, s36, 1
  s_cmp_eq_u32 s36, 7
  s_cselect_b32 s35, s77, 18432
  s_cselect_b32 s36, 0, s36
  s_add_u32 s33, s33, s35
  s_add_u32 s30, s30, 1
  s_cmp_lt_u32 s30, 19
  s_cbranch_scc1 L_p5_ll_99
  s_waitcnt vmcnt(16)
  s_barrier
  s_waitcnt vmcnt(12)
  s_barrier
  s_waitcnt vmcnt(8)
  s_barrier
  s_waitcnt vmcnt(4)
  s_barrier
  s_waitcnt vmcnt(0)
  s_barrier
L_p5_ldT_91:
  s_barrier
L_p5_join_88:
L_end_1:
  s_endpgm
L_skip_28:
  v_mov_b32 v104, 0xf149f2ca
  v_mov_b32 v105, 0xf149f2ca
  v_mov_b32 v106, 0xf149f2ca
  v_mov_b32 v107, 0xf149f2ca
  s_branch L_back_29
L_skip_30:
  v_mov_b32 v112, 0xf149f2ca
  v_mov_b32 v113, 0xf149f2ca
  v_mov_b32 v114, 0xf149f2ca
  v_mov_b32 v115, 0xf149f2ca
  v_mov_b32 v116, 0xf149f2ca
  v_mov_b32 v117, 0xf149f2ca
  v_mov_b32 v118, 0xf149f2ca
  v_mov_b32 v119, 0xf149f2ca
  s_branch L_back_31
L_skip_32:
  v_mov_b32 v120, 0xf149f2ca
  v_mov_b32 v121, 0xf149f2ca
  v_mov_b32 v122, 0xf149f2ca
  v_mov_b32 v123, 0xf149f2ca
  v_mov_b32 v124, 0xf149f2ca
  v_mov_b32 v125, 0xf149f2ca
  v_mov_b32 v126, 0xf149f2ca
  v_mov_b32 v127, 0xf149f2ca
  s_branch L_back_33
L_skip_34:
  v_mov_b32 v128, 0xf149f2ca
  v_mov_b32 v129, 0xf149f2ca
  v_mov_b32 v130, 0xf149f2ca
  v_mov_b32 v131, 0xf149f2ca
  v_mov_b32 v132, 0xf149f2ca
  v_mov_b32 v133, 0xf149f2ca
  v_mov_b32 v134, 0xf149f2ca
  v_mov_b32 v135, 0xf149f2ca
  s_branch L_back_35
L_skip_36:
  v_mov_b32 v136, 0xf149f2ca
  v_mov_b32 v137, 0xf149f2ca
  v_mov_b32 v138, 0xf149f2ca
  v_mov_b32 v139, 0xf149f2ca
  v_mov_b32 v140, 0xf149f2ca
  v_mov_b32 v141, 0xf149f2ca
  v_mov_b32 v142, 0xf149f2ca
  v_mov_b32 v143, 0xf149f2ca
  s_branch L_back_37
L_skip_38:
  v_mov_b32 v144, 0xf149f2ca
  v_mov_b32 v145, 0xf149f2ca
  v_mov_b32 v146, 0xf149f2ca
  v_mov_b32 v147, 0xf149f2ca
  v_mov_b32 v148, 0xf149f2ca
  v_mov_b32 v149, 0xf149f2ca
  v_mov_b32 v150, 0xf149f2ca
  v_mov_b32 v151, 0xf149f2ca
  s_branch L_back_39
L_skip_40:
  v_mov_b32 v152, 0xf149f2ca
  v_mov_b32 v153, 0xf149f2ca
  v_mov_b32 v154, 0xf149f2ca
  v_mov_b32 v155, 0xf149f2ca
  v_mov_b32 v156, 0xf149f2ca
  v_mov_b32 v157, 0xf149f2ca
  v_mov_b32 v158, 0xf149f2ca
  v_mov_b32 v159, 0xf149f2ca
  s_branch L_back_41
L_skip_42:
  v_mov_b32 v160, 0xf149f2ca
  v_mov_b32 v161, 0xf149f2ca
  v_mov_b32 v162, 0xf149f2ca
  v_mov_b32 v163, 0xf149f2ca
  v_mov_b32 v164, 0xf149f2ca
  v_mov_b32 v165, 0xf149f2ca
  v_mov_b32 v166, 0xf149f2ca
  v_mov_b32 v167, 0xf149f2ca
  s_branch L_back_43
L_skip_44:
  v_mov_b32 v168, 0xf149f2ca
  v_mov_b32 v169, 0xf149f2ca
  v_mov_b32 v170, 0xf149f2ca
  v_mov_b32 v171, 0xf149f2ca
  v_mov_b32 v172, 0xf149f2ca
  v_mov_b32 v173, 0xf149f2ca
  v_mov_b32 v174, 0xf149f2ca
  v_mov_b32 v175, 0xf149f2ca
  s_branch L_back_45
L_skip_46:
  v_mov_b32 v176, 0xf149f2ca
  v_mov_b32 v177, 0xf149f2ca
  v_mov_b32 v178, 0xf149f2ca
  v_mov_b32 v179, 0xf149f2ca
  v_mov_b32 v180, 0xf149f2ca
  v_mov_b32 v181, 0xf149f2ca
  v_mov_b32 v182, 0xf149f2ca
  v_mov_b32 v183, 0xf149f2ca
  s_branch L_back_47
L_skip_48:
  v_mov_b32 v184, 0xf149f2ca
  v_mov_b32 v185, 0xf149f2ca
  v_mov_b32 v186, 0xf149f2ca
  v_mov_b32 v187, 0xf149f2ca
  v_mov_b32 v188, 0xf149f2ca
  v_mov_b32 v189, 0xf149f2ca
  v_mov_b32 v190, 0xf149f2ca
  v_mov_b32 v191, 0xf149f2ca
  s_branch L_back_49
L_skip_50:
  v_mov_b32 v192, 0xf149f2ca
  v_mov_b32 v193, 0xf149f2ca
  v_mov_b32 v194, 0xf149f2ca
  v_mov_b32 v195, 0xf149f2ca
  v_mov_b32 v196, 0xf149f2ca
  v_mov_b32 v197, 0xf149f2ca
  v_mov_b32 v198, 0xf149f2ca
  v_mov_b32 v199, 0xf149f2ca
  s_branch L_back_51
L_skip_52:
  v_mov_b32 v200, 0xf149f2ca
  v_mov_b32 v201, 0xf149f2ca
  v_mov_b32 v202, 0xf149f2ca
  v_mov_b32 v203, 0xf149f2ca
  v_mov_b32 v204, 0xf149f2ca
  v_mov_b32 v205, 0xf149f2ca
  v_mov_b32 v206, 0xf149f2ca
  v_mov_b32 v207, 0xf149f2ca
  s_branch L_back_53
L_skip_54:
  v_mov_b32 v208, 0xf149f2ca
  v_mov_b32 v209, 0xf149f2ca
  v_mov_b32 v210, 0xf149f2ca
  v_mov_b32 v211, 0xf149f2ca
  v_mov_b32 v212, 0xf149f2ca
  v_mov_b32 v213, 0xf149f2ca
  v_mov_b32 v214, 0xf149f2ca
  v_mov_b32 v215, 0xf149f2ca
  s_branch L_back_55
L_skip_56:
  v_mov_b32 v216, 0xf149f2ca
  v_mov_b32 v217, 0xf149f2ca
  v_mov_b32 v218, 0xf149f2ca
  v_mov_b32 v219, 0xf149f2ca
  v_mov_b32 v220, 0xf149f2ca
  v_mov_b32 v221, 0xf149f2ca
  v_mov_b32 v222, 0xf149f2ca
  v_mov_b32 v223, 0xf149f2ca
  s_branch L_back_57
L_skip_58:
  v_mov_b32 v224, 0xf149f2ca
  v_mov_b32 v225, 0xf149f2ca
  v_mov_b32 v226, 0xf149f2ca
  v_mov_b32 v227, 0xf149f2ca
  v_mov_b32 v228, 0xf149f2ca
  v_mov_b32 v229, 0xf149f2ca
  v_mov_b32 v230, 0xf149f2ca
  v_mov_b32 v231, 0xf149f2ca
  s_branch L_back_59
.section .rodata,"a"
.p2align 6
.amdhsa_kernel sequential_preLN__sliding_block__dense_activation_relu__prompt_kernel
  .amdhsa_next_free_vgpr 256
  .amdhsa_next_free_sgpr 102
  .amdhsa_accum_offset 256
  .amdhsa_group_segment_fixed_size 0
  .amdhsa_kernarg_size 72
  .amdhsa_user_sgpr_count 2
  .amdhsa_user_sgpr_kernarg_segment_ptr 1
  .amdhsa_system_sgpr_workgroup_id_x 1
.end_amdhsa_kernel
```
